```python
import torch

def _softmax(x, axis=-1):
    return torch.softmax(x, dim=axis)
def _gelu(x):
    return torch.nn.functional.gelu(x, approximate="tanh")
def _silu(x):
    return torch.nn.functional.silu(x)
def _sigmoid(x):
    return torch.sigmoid(x)
def _layernorm(x, axis=-1, eps=1e-5):
    m = x.mean(dim=axis, keepdim=True)
    v = x.var(dim=axis, keepdim=True, unbiased=False)
    return (x - m) / torch.sqrt(v + eps)
def _scatter_add(tgt, idx, src, axis=0):
    return tgt.clone().index_add_(axis, idx, src)
def _segment_sum(src, seg, n):
    out = torch.zeros((n,) + src.shape[1:], dtype=src.dtype)
    return out.index_add_(0, seg, src)
def _pad(x, pw):
    flat = tuple(v for pair in reversed(pw) for v in pair)
    return torch.nn.functional.pad(x, flat)

kernel_name = 'interleave_layers__ssm_conv_h3__swiglu_ffn__prompt'

def setup_inputs():

    _w = (lambda a: (lambda t: t.to(torch.bfloat16) if t.is_floating_point() else t)(torch.as_tensor(a)))
    def _A_setup():
        B, S, D = 1, 2048, 512
        ks = 4
        return {
            "q": _w((lambda *s: torch.randn(*s, dtype=torch.bfloat16) * 0.05)(B, S, D)),
            "k": _w((lambda *s: torch.randn(*s, dtype=torch.bfloat16) * 1.6)(B, S, D)),
            "v": _w((lambda *s: torch.randn(*s, dtype=torch.bfloat16) * 1.6)(B, S, D)),
            "shift_k": _w((lambda *s: torch.randn(*s, dtype=torch.bfloat16) * 1.6)(D, ks) * 0.5),
            "ssm_k": _w((lambda *s: torch.randn(*s, dtype=torch.bfloat16) * 1.6)(D, S) * (1.0 / S ** 0.5)),
            "ssm_D": _w((lambda *s: torch.randn(*s, dtype=torch.bfloat16) * 1.6)(D)),
        }
    _A_in = _A_setup()

    def _B_setup():
        B, S, D, F = 1, 2048, 512, 1792
        return {
            "x": _w((lambda *s: torch.randn(*s, dtype=torch.bfloat16) * 0.05)(B, S, D)),
            "w_gate": _w((lambda *s: torch.randn(*s, dtype=torch.bfloat16) * 0.2)(D, F)),
            "w_up": _w((lambda *s: torch.randn(*s, dtype=torch.bfloat16) * 0.2)(D, F)),
            "w_down": _w((lambda *s: torch.randn(*s, dtype=torch.bfloat16) * 0.2)(F, D)),
        }
    _B_in = _B_setup()

    return {
        "A_q": _A_in["q"],
        "A_k": _A_in["k"],
        "A_v": _A_in["v"],
        "A_shift_k": _A_in["shift_k"],
        "A_ssm_k": _A_in["ssm_k"],
        "A_ssm_D": _A_in["ssm_D"],
        "B_x": _B_in["x"],
        "B_w_gate": _B_in["w_gate"],
        "B_w_up": _B_in["w_up"],
        "B_w_down": _B_in["w_down"],
    }

def reference(A_q, A_k, A_v, A_shift_k, A_ssm_k, A_ssm_D, B_x, B_w_gate, B_w_up, B_w_down):
    def _A_ref(q, k, v, shift_k, ssm_k, ssm_D):
        B, S, D = q.shape
        ks = shift_k.shape[-1]
        k_pad = _pad(k, ((0, 0), (ks - 1, 0), (0, 0)))
        k_shift = torch.zeros_like(k)
        for t in range(ks):
            k_shift = k_shift + k_pad[:, t:t + S, :] * shift_k[:, ks - 1 - t][None, None, :]
        kv = k_shift * v
        L = 2 * S
        kv_pad = _pad(kv, ((0, 0), (0, S), (0, 0)))
        kf_pad = _pad(ssm_k, ((0, 0), (0, S)))
        kv_f = (lambda x, axes=(-2,-1): torch.fft.rfft2(x.float(), dim=axes))(kv_pad[:, None, :, :], axes=(1, 2))
        kf_f = (lambda x, axes=(-2,-1): torch.fft.rfft2(x.float(), dim=axes))(kf_pad[:, None, :], axes=(1, 2))
        kf_f = (lambda x, *d: x.permute(*d))(kf_f, 1, 2, 0)
        y_f = kv_f * kf_f[None, :, :, :]
        y = (lambda x, s, axes=(-2,-1): torch.fft.irfft2(x, s=s, dim=axes).to(torch.bfloat16))(y_f, (1, L), axes=(1, 2))[:, 0, :S, :]
        y = y + kv * ssm_D[None, None, :]
        return q * y

    def _B_ref(x, w_gate, w_up, w_down):
        g = _silu(x @ w_gate)
        u = x @ w_up
        return (g * u) @ w_down

    x = A_q
    x = x + _A_ref(_layernorm(x, axis=-1), A_k, A_v, A_shift_k, A_ssm_k, A_ssm_D)
    x = x + _B_ref(_layernorm(x, axis=-1), B_w_gate, B_w_up, B_w_down)
    x = x + _A_ref(_layernorm(x, axis=-1), A_k, A_v, A_shift_k, A_ssm_k, A_ssm_D)
    x = x + _B_ref(_layernorm(x, axis=-1), B_w_gate, B_w_up, B_w_down)
    return x
```

```asm
; @launch grid=(256,1,1) block=(256,1,1) lds=163840
.amdgcn_target "amdgcn-amd-amdhsa--gfx950"
.text
.globl interleave_layers__ssm_conv_h3__swiglu_ffn__prompt_kernel
.p2align 8
.type interleave_layers__ssm_conv_h3__swiglu_ffn__prompt_kernel,@function
interleave_layers__ssm_conv_h3__swiglu_ffn__prompt_kernel:
    s_cmp_ge_u32 s2, 256
    s_cbranch_scc1 L_END
    s_load_dwordx2 s[44:45], s[0:1], 8
    s_load_dwordx2 s[48:49], s[0:1], 16
    s_load_dwordx2 s[76:77], s[0:1], 96
    s_load_dwordx2 s[52:53], s[0:1], 32
    s_load_dwordx2 s[80:81], s[0:1], 24
    s_load_dwordx2 s[56:57], s[0:1], 0
    s_load_dwordx2 s[60:61], s[0:1], 56
    s_load_dwordx2 s[64:65], s[0:1], 64
    s_load_dwordx2 s[68:69], s[0:1], 72
    s_load_dwordx2 s[72:73], s[0:1], 80
    s_load_dwordx2 s[34:35], s[0:1], 40
    s_lshr_b32 s5, s2, 3
    s_getpc_b64 s[14:15]
L_PC:
    s_mul_i32 s16, s5, ((L_LAST-L_PC+4095)/4096)*128
    v_min_u32 v5, (L_LAST-L_PC+4095)/4096-1, v0
    v_lshl_add_u32 v5, v5, 7, s16
    v_min_u32 v5, L_LAST-L_PC-4, v5
    global_load_dword v219, v5, s[14:15]
    s_and_b32 s4, s2, 7
    v_lshrrev_b32 v5, 6, v0
    v_and_b32 v1, 63, v0
    v_readfirstlane_b32 s6, v5
    v_lshlrev_b32 v2, 4, v1
    s_mov_b32 s46, 2097152
    s_mov_b32 s47, 0x20000
    s_mov_b32 s50, 2097152
    s_mov_b32 s51, 0x20000
    s_mov_b32 s78, 17825792
    s_mov_b32 s79, 0x20000
    s_mov_b32 s54, 2097152
    s_mov_b32 s55, 0x20000
    s_mov_b32 s82, 4096
    s_mov_b32 s83, 0x20000
    v_lshrrev_b32 v24, 3, v1
    v_and_b32 v25, 7, v1
    v_and_b32 v26, 2, v24
    v_xor_b32 v25, v25, v26
    s_and_b32 s12, s6, 1
    s_lshl_b32 s12, s12, 2
    v_xor_b32 v25, s12, v25
    v_lshlrev_b32 v25, 4, v25
    v_lshl_add_u32 v25, v24, 10, v25
    s_lshl_b32 s12, s5, 16
    s_lshl_b32 s13, s6, 14
    s_lshl_b32 s14, s4, 7
    s_add_u32 s12, s12, s13
    s_add_u32 s12, s12, s14
    v_add_u32 v25, s12, v25
    v_xor_b32 v26, 64, v25
    v_subrev_u32 v26, 8192, v26
    s_lshl_b32 s13, s6, 11
    s_add_u32 s14, s13, 115712
    s_add_u32 s15, s13, 123904
    s_movk_i32 s16, 8192
    v_and_b32 v27, 15, v1
    s_lshl_b32 s12, s4, 6
    s_lshl_b32 s13, s6, 4
    s_add_u32 s13, s12, s13
    v_add_u32 v27, s13, v27
    v_lshlrev_b32 v28, 3, v27
    s_lshl_b32 s13, s5, 1
    s_add_u32 s12, s12, s13
    s_lshl_b32 s17, s12, 1
    s_lshl_b32 s18, s12, 12
    s_add_u32 s19, s18, 4096
    v_lshlrev_b32 v29, 4, v0
    s_waitcnt lgkmcnt(0)
    s_load_dword s7, s[76:77], 0
    s_load_dword s28, s[34:35], s17
    s_mov_b32 m0, s14
    s_nop 0
    buffer_load_dwordx4 v25, s[44:47], 0 offen lds
    s_mov_b32 m0, s15
    s_nop 0
    buffer_load_dwordx4 v25, s[48:51], 0 offen lds
    s_add_u32 m0, s14, 1024
    s_nop 0
    buffer_load_dwordx4 v25, s[44:47], s16 offen lds
    s_add_u32 m0, s15, 1024
    s_nop 0
    buffer_load_dwordx4 v25, s[48:51], s16 offen lds
    s_cmp_lg_u32 s6, 0
    s_cbranch_scc1 L1
    s_mov_b32 m0, 114688
    s_nop 0
    buffer_load_dwordx4 v26, s[44:47], 0 offen lds
L1:
    buffer_load_dwordx2 v[30:31], v28, s[80:83], 0 offen
    s_getreg_b32 s10, hwreg(HW_REG_XCC_ID, 0, 4)
    v_cmp_eq_u32 vcc, 0, v1
    v_mov_b32 v5, 0x80000000
    s_lshl_b32 s13, s4, 5
    s_add_u32 s13, s13, s5
    s_mul_i32 s13, s13, 4
    s_add_u32 s13, s13, 4096
    s_cmp_eq_u32 s6, 2
    s_cselect_b32 s13, s13, 0x40000000
    v_cndmask_b32 v3, v5, 0, vcc
    s_waitcnt lgkmcnt(0)
    s_mul_i32 s7, s7, 1664525
    s_add_u32 s7, s7, 1013904223
    s_xor_b32 s12, s7, s10
    v_mov_b32 v5, s12
    v_mov_b32 v4, s7
    buffer_store_dword v5, v3, s[76:79], s13 offen sc1
    s_mov_b32 s58, 2097152
    s_mov_b32 s59, 0x20000
    s_mov_b32 s62, 1835008
    s_mov_b32 s63, 0x20000
    s_mov_b32 s66, 1835008
    s_mov_b32 s67, 0x20000
    s_mov_b32 s70, 1835008
    s_mov_b32 s71, 0x20000
    s_mov_b32 s74, 2097152
    s_mov_b32 s75, 0x20000
    s_lshr_b32 s30, s28, 16
    s_and_b32 s31, s28, 0xffff0000
    s_lshl_b32 s29, s28, 16
    s_and_b32 s28, s28, 0xffff
    s_mov_b32 s24, 0x40053526
    s_mov_b32 s25, 0x40053526
    s_mov_b32 s9, 400000
    s_mov_b32 s26, 0x20000
    s_mov_b32 s91, 458752
    v_and_b32 v17, 31, v1
    v_lshlrev_b32 v17, 2, v17
    v_and_b32 v18, 7, v1
    v_lshlrev_b32 v18, 2, v18
    s_movk_i32 s84, 4096
    s_movk_i32 s85, 8192
    s_movk_i32 s86, 12288
    s_movk_i32 s87, 16384
    s_movk_i32 s88, 20480
    s_movk_i32 s89, 24576
    s_movk_i32 s90, 28672
    v_and_b32 v24, 15, v1
    v_lshrrev_b32 v25, 4, v1
    v_lshlrev_b32 v5, 3, v25
    v_sub_u32 v26, v24, v5
    v_add_u32 v26, 9, v26
    v_and_b32 v5, 1, v26
    v_sub_u32 v26, v26, v5
    v_lshlrev_b32 v26, 1, v26
    v_mul_u32_u24 v5, 4288, v5
    v_add_u32 v26, v26, v5
    s_lshr_b32 s12, s6, 1
    s_mul_i32 s14, s12, 8448
    s_and_b32 s13, s6, 1
    s_lshl_b32 s15, s13, 8
    s_add_u32 s14, s14, s15
    s_add_u32 s14, s14, 132160
    v_add_u32 v152, s14, v26
    s_mul_i32 s16, s12, 4608
    s_add_u32 s16, s16, 149632
    s_lshl_b32 s14, s13, 11
    s_add_u32 s46, s16, s14
    s_sub_u32 s16, s16, s15
    s_sub_u32 s16, s16, 224
    v_lshlrev_b32 v140, 5, v24
    v_lshl_add_u32 v140, v25, 4, v140
    v_add_u32 v140, s16, v140
    s_lshl_b32 s12, s4, 9
    s_lshr_b32 s13, s5, 3
    s_lshl_b32 s13, s13, 7
    s_add_u32 s13, s12, s13
    s_add_u32 s44, s13, 65536
    s_lshl_b32 s13, s5, 4
    s_add_u32 s12, s12, s13
    s_add_u32 s50, s12, 3145728
    s_lshl_b32 s12, s4, 18
    s_lshl_b32 s13, s5, 13
    s_add_u32 s12, s12, s13
    s_lshl_b32 s14, s6, 11
    s_add_u32 s13, s12, s14
    s_add_u32 s45, s13, 1048576
    s_lshl_b32 s14, s6, 10
    s_add_u32 s13, s12, s14
    s_add_u32 s47, s13, 3145728
    v_lshlrev_b32 v141, 5, v24
    v_lshrrev_b32 v5, 1, v25
    v_lshl_add_u32 v141, v5, 4, v141
    v_and_b32 v5, 1, v25
    v_xor_b32 v5, 1, v5
    v_lshl_add_u32 v141, v5, 3, v141
    s_lshl_b32 s12, s6, 9
    s_add_u32 s13, s12, 149632
    v_add_u32 v141, s13, v141
    s_add_u32 s13, s14, 149120
    v_add_u32 v149, s13, v2
    s_lshl_b32 s12, s6, 12
    s_add_u32 s12, s12, 57344
    v_add_u32 v142, s12, v2
    s_add_u32 s12, s14, 57344
    v_add_u32 v143, s12, v2
    v_lshlrev_b32 v144, 6, v24
    v_lshl_add_u32 v144, v25, 4, v144
    v_add_u32 v145, 4096, v144
    s_lshl_b32 s12, s4, 5
    s_add_u32 s12, s12, s5
    s_lshl_b32 s12, s12, 2
    s_add_u32 s12, s12, s14
    s_mul_i32 s12, s12, 1
    s_add_u32 s48, s12, 262144
    v_lshlrev_b32 v148, 2, v0
    v_mul_u32_u24 v146, 4, v0
    s_lshr_b32 s12, s4, 1
    s_mul_i32 s12, s12, 1024
    s_add_u32 s49, s12, 262144
    v_lshlrev_b32 v147, 13, v0
    v_add_u32 v148, 149120, v148
    v_add_u32 v153, 512, v152
    v_add_u32 v154, 1024, v152
    v_add_u32 v155, 1536, v152
    v_add_u32 v156, 2048, v152
    v_add_u32 v157, 2560, v152
    v_add_u32 v158, 3072, v152
    v_add_u32 v159, 3584, v152
    buffer_load_dwordx4 v[32:35], v29, s[52:55], s18 offen
    buffer_load_dwordx4 v[40:43], v29, s[52:55], s19 offen
    buffer_load_dwordx4 v[36:39], v29, s[52:55], s18 offen offset:2
    buffer_load_dwordx4 v[44:47], v29, s[52:55], s19 offen offset:2
    v_and_b32 v5, 15, v1
    v_lshlrev_b32 v5, 7, v5
    buffer_load_dword v220, v5, s[76:79], s45 offen sc1
    s_lshl_b32 s12, s4, 12
    s_add_u32 s12, s12, 69632
    v_lshl_add_u32 v22, v1, 7, s12
    v_cmp_lt_u32 vcc, 15, v1
    v_add_u32 v5, 30720, v22
    s_lshl_b32 s12, s4, 9
    v_cndmask_b32 v22, v22, v5, vcc
    v_cmp_lt_u32 vcc, 47, v1
    v_add_u32 v5, 28672, v22
    s_add_u32 s12, s12, 65536
    v_cndmask_b32 v22, v22, v5, vcc
    v_cmp_lt_u32 vcc, 55, v1
    v_and_b32 v5, 3, v1
    v_lshl_add_u32 v5, v5, 7, s12
    s_cmp_eq_u32 s6, 3
    s_cselect_b32 s12, 0, 0x40000000
    v_cndmask_b32 v5, v22, v5, vcc
    buffer_load_dword v221, v5, s[76:79], s12 offen sc1
    v_lshlrev_b32 v5, 7, v1
    s_lshl_b32 s13, s4, 2
    s_and_b32 s13, s13, 0x1c
    s_or_b32 s13, s13, s6
    s_cmp_eq_u32 s13, 1
    s_cselect_b32 s12, s5, 31
    s_lshl_b32 s13, s12, 13
    s_cmp_lt_u32 s12, 2
    s_cselect_b32 s12, s13, 0x40000000
    s_add_u32 s12, s12, 253952
    buffer_load_dword v202, v5, s[76:79], s12 offen sc1
    s_mul_i32 s12, s5, 112
    s_movk_i32 s13, 9363
    s_movk_i32 s14, 3472
    s_mul_i32 s27, s6, 229376
    s_mul_i32 s3, s6, 14336
    s_and_b32 s15, s4, 6
    s_and_b32 s16, s4, 1
    s_cselect_b32 s17, s64, s60
    s_cselect_b32 s18, s65, s61
    s_cselect_b32 s64, s60, s64
    s_cselect_b32 s65, s61, s65
    s_cselect_b32 s16, 7168, 0
    s_lshl_b32 s82, s16, 1
    s_sub_u32 s82, 7168, s82
    s_mov_b32 s60, s17
    s_mov_b32 s61, s18
    s_add_u32 s83, s82, 57344
    s_add_u32 s16, s16, s3
    s_add_u32 s17, s15, 0
    s_sub_u32 s18, s17, 7
    s_cselect_b32 s17, s17, s18
    s_lshl_b32 s18, s17, 10
    s_add_u32 s0, s18, s16
    v_lshl_add_u32 v5, s17, 6, v1
    v_mul_u32_u24 v212, s13, v5
    v_lshrrev_b32 v212, 16, v212
    v_mul_u32_u24 v212, s14, v212
    v_lshl_add_u32 v212, v5, 4, v212
    v_add_u32 v212, s12, v212
    s_add_u32 s17, s15, 1
    s_sub_u32 s18, s17, 7
    s_cselect_b32 s17, s17, s18
    s_lshl_b32 s18, s17, 10
    s_add_u32 s1, s18, s16
    v_lshl_add_u32 v5, s17, 6, v1
    v_mul_u32_u24 v213, s13, v5
    v_lshrrev_b32 v213, 16, v213
    v_mul_u32_u24 v213, s14, v213
    v_lshl_add_u32 v213, v5, 4, v213
    v_add_u32 v213, s12, v213
    s_add_u32 s17, s15, 2
    s_sub_u32 s18, s17, 7
    s_cselect_b32 s17, s17, s18
    s_lshl_b32 s18, s17, 10
    s_add_u32 s34, s18, s16
    v_lshl_add_u32 v5, s17, 6, v1
    v_mul_u32_u24 v214, s13, v5
    v_lshrrev_b32 v214, 16, v214
    v_mul_u32_u24 v214, s14, v214
    v_lshl_add_u32 v214, v5, 4, v214
    v_add_u32 v214, s12, v214
    s_add_u32 s17, s15, 3
    s_sub_u32 s18, s17, 7
    s_cselect_b32 s17, s17, s18
    s_lshl_b32 s18, s17, 10
    s_add_u32 s35, s18, s16
    v_lshl_add_u32 v5, s17, 6, v1
    v_mul_u32_u24 v215, s13, v5
    v_lshrrev_b32 v215, 16, v215
    v_mul_u32_u24 v215, s14, v215
    v_lshl_add_u32 v215, v5, 4, v215
    v_add_u32 v215, s12, v215
    s_add_u32 s17, s15, 4
    s_sub_u32 s18, s17, 7
    s_cselect_b32 s17, s17, s18
    s_lshl_b32 s18, s17, 10
    s_add_u32 s54, s18, s16
    v_lshl_add_u32 v5, s17, 6, v1
    v_mul_u32_u24 v216, s13, v5
    v_lshrrev_b32 v216, 16, v216
    v_mul_u32_u24 v216, s14, v216
    v_lshl_add_u32 v216, v5, 4, v216
    v_add_u32 v216, s12, v216
    s_add_u32 s17, s15, 5
    s_sub_u32 s18, s17, 7
    s_cselect_b32 s17, s17, s18
    s_lshl_b32 s18, s17, 10
    s_add_u32 s80, s18, s16
    v_lshl_add_u32 v5, s17, 6, v1
    v_mul_u32_u24 v217, s13, v5
    v_lshrrev_b32 v217, 16, v217
    v_mul_u32_u24 v217, s14, v217
    v_lshl_add_u32 v217, v5, 4, v217
    v_add_u32 v217, s12, v217
    s_add_u32 s17, s15, 6
    s_sub_u32 s18, s17, 7
    s_cselect_b32 s17, s17, s18
    s_lshl_b32 s18, s17, 10
    s_add_u32 s81, s18, s16
    v_lshl_add_u32 v5, s17, 6, v1
    v_mul_u32_u24 v218, s13, v5
    v_lshrrev_b32 v218, 16, v218
    v_mul_u32_u24 v218, s14, v218
    v_lshl_add_u32 v218, v5, 4, v218
    v_add_u32 v218, s12, v218
    s_add_u32 m0, s0, 0
    s_nop 0
    buffer_load_dwordx4 v212, s[60:63], s27 offen lds
    s_add_u32 m0, s1, 0
    s_nop 0
    buffer_load_dwordx4 v213, s[60:63], s27 offen lds
    s_lshl_b32 s12, s2, 1
    s_lshr_b32 s13, s6, 1
    s_add_u32 s12, s12, s13
    s_mul_i32 s13, s12, 4682
    s_lshr_b32 s13, s13, 16
    s_mul_i32 s14, s13, 14
    s_sub_u32 s14, s12, s14
    s_and_b32 s15, s13, 3
    s_lshr_b32 s13, s13, 2
    s_lshl_b32 s13, s13, 7
    s_mul_i32 s15, s15, 458752
    s_add_u32 s13, s13, s15
    s_cmp_lt_u32 s2, 224
    s_cselect_b32 s15, s6, 0
    s_bitcmp1_b32 s15, 0
    s_cselect_b32 s15, 0, 0x80000000
    s_mul_i32 s16, s12, 4
    s_add_u32 s16, s16, 253952
    s_lshr_b32 s51, s15, 1
    s_or_b32 s51, s51, s16
    s_lshl_b32 s12, s12, 12
    s_add_u32 s12, s12, 14680064
    s_or_b32 s12, s12, s15
    s_or_b32 s13, s13, s15
    v_add_u32 v195, s12, v2
    v_lshrrev_b32 v5, 3, v1
    v_and_b32 v22, 3, v5
    v_lshlrev_b32 v22, 3, v22
    v_cmp_gt_u32 vcc, 4, v5
    v_lshl_add_u32 v23, v18, 2, s13
    s_lshl_b32 s14, s14, 2
    s_add_u32 s12, s14, 0
    s_mul_i32 s13, s12, 9363
    s_lshr_b32 s13, s13, 16
    s_mul_i32 s15, s13, 7
    s_sub_u32 s12, s12, s15
    s_mul_i32 s13, s13, 56
    s_mul_i32 s15, s12, 0x04040404
    s_add_u32 s16, s15, 0x13121110
    s_add_u32 s15, s15, 0x03020100
    s_cmp_ge_u32 s12, 4
    s_cselect_b32 s15, s16, s15
    s_cselect_b32 s16, 757870896, s16
    s_cmp_eq_u32 s12, 5
    s_cselect_b32 s16, 791556914, s16
    s_cmp_eq_u32 s12, 6
    s_cselect_b32 s16, 926299444, s16
    v_mov_b32 v5, s15
    v_mov_b32 v190, s16
    v_cndmask_b32 v5, v190, v5, vcc
    v_bfe_u32 v5, v5, v22, 8
    v_add_u32 v5, s13, v5
    v_lshl_add_u32 v190, v5, 10, v23
    s_add_u32 s12, s14, 1
    s_mul_i32 s13, s12, 9363
    s_lshr_b32 s13, s13, 16
    s_mul_i32 s15, s13, 7
    s_sub_u32 s12, s12, s15
    s_mul_i32 s13, s13, 56
    s_mul_i32 s15, s12, 0x04040404
    s_add_u32 s16, s15, 0x13121110
    s_add_u32 s15, s15, 0x03020100
    s_cmp_ge_u32 s12, 4
    s_cselect_b32 s15, s16, s15
    s_cselect_b32 s16, 757870896, s16
    s_cmp_eq_u32 s12, 5
    s_cselect_b32 s16, 791556914, s16
    s_cmp_eq_u32 s12, 6
    s_cselect_b32 s16, 926299444, s16
    v_mov_b32 v5, s15
    v_mov_b32 v191, s16
    v_cndmask_b32 v5, v191, v5, vcc
    v_bfe_u32 v5, v5, v22, 8
    v_add_u32 v5, s13, v5
    v_lshl_add_u32 v191, v5, 10, v23
    s_add_u32 s12, s14, 2
    s_mul_i32 s13, s12, 9363
    s_lshr_b32 s13, s13, 16
    s_mul_i32 s15, s13, 7
    s_sub_u32 s12, s12, s15
    s_mul_i32 s13, s13, 56
    s_mul_i32 s15, s12, 0x04040404
    s_add_u32 s16, s15, 0x13121110
    s_add_u32 s15, s15, 0x03020100
    s_cmp_ge_u32 s12, 4
    s_cselect_b32 s15, s16, s15
    s_cselect_b32 s16, 757870896, s16
    s_cmp_eq_u32 s12, 5
    s_cselect_b32 s16, 791556914, s16
    s_cmp_eq_u32 s12, 6
    s_cselect_b32 s16, 926299444, s16
    v_mov_b32 v5, s15
    v_mov_b32 v192, s16
    v_cndmask_b32 v5, v192, v5, vcc
    v_bfe_u32 v5, v5, v22, 8
    v_add_u32 v5, s13, v5
    v_lshl_add_u32 v192, v5, 10, v23
    s_add_u32 s12, s14, 3
    s_mul_i32 s13, s12, 9363
    s_lshr_b32 s13, s13, 16
    s_mul_i32 s15, s13, 7
    s_sub_u32 s12, s12, s15
    s_mul_i32 s13, s13, 56
    s_mul_i32 s15, s12, 0x04040404
    s_add_u32 s16, s15, 0x13121110
    s_add_u32 s15, s15, 0x03020100
    s_cmp_ge_u32 s12, 4
    s_cselect_b32 s15, s16, s15
    s_cselect_b32 s16, 757870896, s16
    s_cmp_eq_u32 s12, 5
    s_cselect_b32 s16, 791556914, s16
    s_cmp_eq_u32 s12, 6
    s_cselect_b32 s16, 926299444, s16
    v_mov_b32 v5, s15
    v_mov_b32 v193, s16
    v_cndmask_b32 v5, v193, v5, vcc
    v_bfe_u32 v5, v5, v22, 8
    v_add_u32 v5, s13, v5
    v_lshl_add_u32 v193, v5, 10, v23
    s_lshl_b32 s52, s6, 12
    s_add_u32 s52, s52, 98304
    v_lshrrev_b32 v5, 4, v1
    v_lshlrev_b32 v194, 10, v5
    v_bfe_u32 v5, v1, 2, 2
    v_lshl_add_u32 v194, v5, 7, v194
    v_and_b32 v5, 3, v1
    v_lshl_add_u32 v194, v5, 3, v194
    v_add_u32 v194, s52, v194
    v_lshrrev_b32 v5, 4, v1
    v_bfe_u32 v48, v1, 2, 2
    v_lshl_add_u32 v49, v5, 4, v48
    v_lshlrev_b32 v49, 7, v49
    v_bfe_u32 v50, v1, 1, 1
    s_lshl_b32 s12, s6, 1
    v_add_u32 v50, s12, v50
    v_and_b32 v48, 2, v48
    v_xor_b32 v50, v50, v48
    v_and_b32 v48, 1, v5
    v_lshlrev_b32 v48, 2, v48
    v_xor_b32 v50, v50, v48
    v_lshl_add_u32 v49, v50, 4, v49
    v_and_b32 v48, 1, v1
    v_lshl_add_u32 v49, v48, 3, v49
    v_add_u32 v49, 114688, v49
    v_xor_b32 v50, 64, v49
    v_lshlrev_b32 v51, 12, v27
    v_lshl_add_u32 v51, v5, 5, v51
    s_lshl_b32 s18, s5, 7
    s_add_u32 s18, s18, 1048576
    v_mul_u32_u24 v52, 1, v17
    s_mul_i32 s19, s4, 128
    s_add_u32 s19, s19, 4096
    s_lshl_b32 s12, s4, 9
    s_lshl_b32 s13, s6, 7
    s_lshl_b32 s14, s5, 2
    s_add_u32 s13, s13, s14
    s_add_u32 s12, s12, 65536
    s_add_u32 s17, s13, s12
    s_xor_b32 s12, s7, s10
    s_mov_b32 s11, 0
    s_mov_b32 s8, s7
    s_waitcnt vmcnt(10)
    s_barrier
    buffer_load_dword v53, v52, s[76:79], s19 offen sc1
    ds_read_b64_tr_b16 v[56:57], v50 offset:512
    ds_read_b64_tr_b16 v[58:59], v49 offset:1024
    ds_read_b64_tr_b16 v[60:61], v49 offset:1536
    ds_read_b64_tr_b16 v[62:63], v49 offset:2048
    ds_read_b64_tr_b16 v[64:65], v49 offset:2560
    ds_read_b64_tr_b16 v[68:69], v49 offset:9216
    ds_read_b64_tr_b16 v[70:71], v49 offset:9728
    ds_read_b64_tr_b16 v[72:73], v49 offset:10240
    ds_read_b64_tr_b16 v[74:75], v49 offset:10752
    v_alignbit_b32 v54, v30, v30, 16
    v_alignbit_b32 v55, v31, v31, 16
    s_waitcnt lgkmcnt(4)
    v_alignbit_b32 v78, v57, v56, 16
    v_alignbit_b32 v79, v58, v57, 16
    v_alignbit_b32 v80, v59, v58, 16
    v_alignbit_b32 v81, v60, v59, 16
    v_alignbit_b32 v82, v61, v60, 16
    v_alignbit_b32 v83, v62, v61, 16
    v_alignbit_b32 v84, v63, v62, 16
    v_alignbit_b32 v85, v64, v63, 16
    v_alignbit_b32 v86, v65, v64, 16
    v_dot2_f32_bf16 v88, v78, v55, 0
    v_dot2_f32_bf16 v89, v57, v55, 0
    v_dot2_f32_bf16 v90, v79, v55, 0
    v_dot2_f32_bf16 v91, v58, v55, 0
    v_dot2_f32_bf16 v92, v80, v55, 0
    v_dot2_f32_bf16 v93, v59, v55, 0
    v_dot2_f32_bf16 v94, v81, v55, 0
    v_dot2_f32_bf16 v95, v60, v55, 0
    v_dot2_f32_bf16 v96, v82, v55, 0
    v_dot2_f32_bf16 v97, v61, v55, 0
    v_dot2_f32_bf16 v98, v83, v55, 0
    v_dot2_f32_bf16 v99, v62, v55, 0
    v_dot2_f32_bf16 v100, v84, v55, 0
    v_dot2_f32_bf16 v101, v63, v55, 0
    v_dot2_f32_bf16 v102, v85, v55, 0
    v_dot2_f32_bf16 v103, v64, v55, 0
    v_dot2_f32_bf16 v88, v79, v54, v88
    v_dot2_f32_bf16 v89, v58, v54, v89
    v_dot2_f32_bf16 v90, v80, v54, v90
    v_dot2_f32_bf16 v91, v59, v54, v91
    v_dot2_f32_bf16 v92, v81, v54, v92
    v_dot2_f32_bf16 v93, v60, v54, v93
    v_dot2_f32_bf16 v94, v82, v54, v94
    v_dot2_f32_bf16 v95, v61, v54, v95
    v_dot2_f32_bf16 v96, v83, v54, v96
    v_dot2_f32_bf16 v97, v62, v54, v97
    v_dot2_f32_bf16 v98, v84, v54, v98
    v_dot2_f32_bf16 v99, v63, v54, v99
    v_dot2_f32_bf16 v100, v85, v54, v100
    v_dot2_f32_bf16 v101, v64, v54, v101
    v_dot2_f32_bf16 v102, v86, v54, v102
    v_dot2_f32_bf16 v103, v65, v54, v103
    s_waitcnt lgkmcnt(0)
    v_lshlrev_b32 v104, 16, v68
    v_and_b32 v105, 0xffff0000, v68
    v_lshlrev_b32 v106, 16, v69
    v_and_b32 v107, 0xffff0000, v69
    v_lshlrev_b32 v108, 16, v70
    v_and_b32 v109, 0xffff0000, v70
    v_lshlrev_b32 v110, 16, v71
    v_and_b32 v111, 0xffff0000, v71
    v_pk_mul_f32 v[88:89], v[88:89], v[104:105]
    v_pk_mul_f32 v[90:91], v[90:91], v[106:107]
    v_pk_mul_f32 v[92:93], v[92:93], v[108:109]
    v_pk_mul_f32 v[94:95], v[94:95], v[110:111]
    v_cvt_pk_bf16_f32 v120, v95, v94
    v_cvt_pk_bf16_f32 v121, v93, v92
    v_cvt_pk_bf16_f32 v122, v91, v90
    v_cvt_pk_bf16_f32 v123, v89, v88
    buffer_store_dwordx4 v[120:123], v51, s[76:79], s18 offen offset:0
    v_lshlrev_b32 v112, 16, v72
    v_and_b32 v113, 0xffff0000, v72
    v_lshlrev_b32 v114, 16, v73
    v_and_b32 v115, 0xffff0000, v73
    v_lshlrev_b32 v116, 16, v74
    v_and_b32 v117, 0xffff0000, v74
    v_lshlrev_b32 v118, 16, v75
    v_and_b32 v119, 0xffff0000, v75
    v_pk_mul_f32 v[96:97], v[96:97], v[112:113]
    v_pk_mul_f32 v[98:99], v[98:99], v[114:115]
    v_pk_mul_f32 v[100:101], v[100:101], v[116:117]
    v_pk_mul_f32 v[102:103], v[102:103], v[118:119]
    v_cvt_pk_bf16_f32 v124, v103, v102
    v_cvt_pk_bf16_f32 v125, v101, v100
    v_cvt_pk_bf16_f32 v126, v99, v98
    v_cvt_pk_bf16_f32 v127, v97, v96
    buffer_store_dwordx4 v[124:127], v51, s[76:79], s18 offen offset:16
    s_waitcnt vmcnt(8)
    v_add_u32 v48, 114688, v29
    ds_write_b128 v48, v[32:35] offset:17472
    ds_write_b128 v48, v[36:39] offset:21760
    ds_write_b128 v48, v[40:43] offset:25920
    ds_write_b128 v48, v[44:47] offset:30208
    s_cmp_lg_u32 s6, 0
    s_cbranch_scc1 L2
    v_readfirstlane_b32 s13, v32
    v_readfirstlane_b32 s14, v40
    v_cmp_eq_u32 vcc, 28, v18
    v_add_u32 v49, 114688, v18
    s_lshl_b32 s13, s13, 16
    s_lshl_b32 s14, s14, 16
    v_mov_b32 v50, 0
    v_mov_b32 v51, 0
    v_mov_b32 v54, s13
    v_mov_b32 v55, s14
    v_cndmask_b32 v54, v50, v54, vcc
    v_cndmask_b32 v55, v50, v55, vcc
    ds_write_b32 v49, v50 offset:17440
    ds_write_b32 v49, v50 offset:25888
    ds_write_b32 v49, v54 offset:21728
    ds_write_b32 v49, v55 offset:30176
    v_lshlrev_b32 v49, 3, v1
    v_add_u32 v49, 149120, v49
    ds_write_b64 v49, v[50:51]
    ds_write_b64 v49, v[50:51] offset:4608
L2:
    s_waitcnt vmcnt(2)
    v_cmp_ne_u32 vcc, s12, v53
    s_cbranch_vccnz L3
L4:
    s_waitcnt vmcnt(0)
    s_cmp_lg_u32 s11, 0
    s_cbranch_scc1 L6
    buffer_store_dword v4, v3, s[76:79], s17 offen offset:0
L7:
    s_waitcnt lgkmcnt(0)
    s_barrier
    s_add_u32 m0, s34, 0
    s_nop 0
    buffer_load_dwordx4 v214, s[60:63], s27 offen lds
    buffer_load_dword v5, v17, s[76:79], s44 offen offset:0 sc1
    ds_read2_b32 a[0:1], v152 offset0:0 offset1:1
    ds_read2_b32 a[2:3], v152 offset0:2 offset1:3
    ds_read2_b32 a[4:5], v153 offset0:0 offset1:1
    ds_read2_b32 a[6:7], v153 offset0:2 offset1:3
    ds_read2_b32 a[8:9], v154 offset0:0 offset1:1
    ds_read2_b32 a[10:11], v154 offset0:2 offset1:3
    ds_read2_b32 a[12:13], v155 offset0:0 offset1:1
    ds_read2_b32 a[14:15], v155 offset0:2 offset1:3
    ds_read2_b32 a[32:33], v152 offset0:16 offset1:17
    ds_read2_b32 a[34:35], v152 offset0:18 offset1:19
    ds_read2_b32 a[36:37], v153 offset0:16 offset1:17
    ds_read2_b32 a[38:39], v153 offset0:18 offset1:19
    ds_read2_b32 a[40:41], v154 offset0:16 offset1:17
    ds_read2_b32 a[42:43], v154 offset0:18 offset1:19
    ds_read2_b32 a[44:45], v155 offset0:16 offset1:17
    ds_read2_b32 a[46:47], v155 offset0:18 offset1:19
    ds_read2_b32 a[64:65], v152 offset0:32 offset1:33
    ds_read2_b32 a[66:67], v152 offset0:34 offset1:35
    ds_read2_b32 a[68:69], v153 offset0:32 offset1:33
    ds_read2_b32 a[70:71], v153 offset0:34 offset1:35
    s_waitcnt vmcnt(0)
    v_cmp_ne_u32 vcc, s8, v5
    s_cbranch_vccnz L8
L9:
    s_mov_b32 m0, s46
    s_nop 0
    buffer_load_dwordx4 v2, s[76:79], s45 offen sc1 lds
    buffer_load_dwordx4 v2, s[76:79], s45 offen offset:1024 sc1 lds
    ds_read2_b32 a[72:73], v154 offset0:32 offset1:33
    ds_read2_b32 a[74:75], v154 offset0:34 offset1:35
    ds_read2_b32 a[76:77], v155 offset0:32 offset1:33
    ds_read2_b32 a[78:79], v155 offset0:34 offset1:35
    ds_read2_b32 a[96:97], v152 offset0:48 offset1:49
    ds_read2_b32 a[98:99], v152 offset0:50 offset1:51
    ds_read2_b32 a[100:101], v153 offset0:48 offset1:49
    ds_read2_b32 a[102:103], v153 offset0:50 offset1:51
    ds_read2_b32 a[104:105], v154 offset0:48 offset1:49
    ds_read2_b32 a[106:107], v154 offset0:50 offset1:51
    ds_read2_b32 a[108:109], v155 offset0:48 offset1:49
    ds_read2_b32 a[110:111], v155 offset0:50 offset1:51
    s_waitcnt vmcnt(0)
    s_barrier
    ds_read_b128 v[64:67], v140 offset:192
    ds_read_b128 v[68:71], v140 offset:704
    ds_read_b128 v[72:75], v140 offset:1216
    ds_read_b128 v[76:79], v140 offset:1728
    ds_read_b128 v[80:83], v140 offset:128
    ds_read_b128 v[84:87], v140 offset:640
    ds_read_b128 v[88:91], v140 offset:1152
    ds_read_b128 v[92:95], v140 offset:1664
    s_add_u32 m0, s52, 0
    s_nop 0
    buffer_load_dwordx4 v190, s[68:71], 0 offen lds
    s_add_u32 m0, s52, 1024
    s_nop 0
    buffer_load_dwordx4 v191, s[68:71], 0 offen lds
    s_add_u32 m0, s52, 2048
    s_nop 0
    buffer_load_dwordx4 v192, s[68:71], 0 offen lds
    s_add_u32 m0, s52, 3072
    s_nop 0
    buffer_load_dwordx4 v193, s[68:71], 0 offen lds
    s_waitcnt lgkmcnt(6)
    v_mfma_f32_16x16x32_bf16 v[96:99], a[0:3], v[64:67], 0
    ds_read2_b32 a[16:17], v156 offset0:0 offset1:1
    v_mfma_f32_16x16x32_bf16 v[100:103], a[4:7], v[64:67], 0
    s_add_u32 m0, s35, 0
    ds_read2_b32 a[18:19], v156 offset0:2 offset1:3
    v_mfma_f32_16x16x32_bf16 v[104:107], a[8:11], v[64:67], 0
    buffer_load_dwordx4 v215, s[60:63], s27 offen lds
    ds_read2_b32 a[20:21], v157 offset0:0 offset1:1
    v_mfma_f32_16x16x32_bf16 v[108:111], a[12:15], v[64:67], 0
    ds_read2_b32 a[22:23], v157 offset0:2 offset1:3
    ds_read_b128 v[64:67], v140 offset:64
    v_mfma_f32_16x16x32_bf16 v[100:103], a[0:3], v[68:71], v[100:103]
    ds_read2_b32 a[24:25], v158 offset0:0 offset1:1
    v_mfma_f32_16x16x32_bf16 v[104:107], a[4:7], v[68:71], v[104:107]
    ds_read2_b32 a[26:27], v158 offset0:2 offset1:3
    v_mfma_f32_16x16x32_bf16 v[108:111], a[8:11], v[68:71], v[108:111]
    ds_read_b128 v[68:71], v140 offset:576
    s_waitcnt lgkmcnt(12)
    v_mfma_f32_16x16x32_bf16 v[104:107], a[0:3], v[72:75], v[104:107]
    ds_read2_b32 a[28:29], v159 offset0:0 offset1:1
    v_mfma_f32_16x16x32_bf16 v[108:111], a[4:7], v[72:75], v[108:111]
    ds_read2_b32 a[30:31], v159 offset0:2 offset1:3
    ds_read_b128 v[72:75], v140 offset:1088
    v_mfma_f32_16x16x32_bf16 v[108:111], a[0:3], v[76:79], v[108:111]
    ds_read_b128 v[76:79], v140 offset:1600
    s_waitcnt lgkmcnt(14)
    v_mfma_f32_16x16x32_bf16 v[96:99], a[32:35], v[80:83], v[96:99]
    ds_read2_b32 a[48:49], v156 offset0:16 offset1:17
    v_mfma_f32_16x16x32_bf16 v[100:103], a[36:39], v[80:83], v[100:103]
    ds_read2_b32 a[50:51], v156 offset0:18 offset1:19
    v_mfma_f32_16x16x32_bf16 v[104:107], a[40:43], v[80:83], v[104:107]
    s_add_u32 m0, s54, 0
    ds_read2_b32 a[52:53], v157 offset0:16 offset1:17
    v_mfma_f32_16x16x32_bf16 v[108:111], a[44:47], v[80:83], v[108:111]
    buffer_load_dwordx4 v216, s[60:63], s27 offen lds
    ds_read_b128 v[80:83], v140 offset:0
    v_mfma_f32_16x16x32_bf16 v[100:103], a[32:35], v[84:87], v[100:103]
    ds_read2_b32 a[54:55], v157 offset0:18 offset1:19
    v_mfma_f32_16x16x32_bf16 v[104:107], a[36:39], v[84:87], v[104:107]
    ds_read2_b32 a[56:57], v158 offset0:16 offset1:17
    v_mfma_f32_16x16x32_bf16 v[108:111], a[40:43], v[84:87], v[108:111]
    ds_read_b128 v[84:87], v140 offset:512
    s_waitcnt lgkmcnt(15)
    v_mfma_f32_16x16x32_bf16 v[104:107], a[32:35], v[88:91], v[104:107]
    ds_read2_b32 a[58:59], v158 offset0:18 offset1:19
    v_mfma_f32_16x16x32_bf16 v[108:111], a[36:39], v[88:91], v[108:111]
    ds_read2_b32 a[60:61], v159 offset0:16 offset1:17
    ds_read_b128 v[88:91], v140 offset:1024
    v_mfma_f32_16x16x32_bf16 v[108:111], a[32:35], v[92:95], v[108:111]
    ds_read_b128 v[92:95], v140 offset:1536
    s_waitcnt lgkmcnt(15)
    v_mfma_f32_16x16x32_bf16 v[96:99], a[64:67], v[64:67], v[96:99]
    ds_read2_b32 a[62:63], v159 offset0:18 offset1:19
    v_mfma_f32_16x16x32_bf16 v[100:103], a[68:71], v[64:67], v[100:103]
    ds_read2_b32 a[80:81], v156 offset0:32 offset1:33
    v_mfma_f32_16x16x32_bf16 v[104:107], a[72:75], v[64:67], v[104:107]
    ds_read2_b32 a[82:83], v156 offset0:34 offset1:35
    v_mfma_f32_16x16x32_bf16 v[108:111], a[76:79], v[64:67], v[108:111]
    s_add_u32 m0, s80, 0
    ds_read_b128 v[64:67], v140 offset:192
    v_mfma_f32_16x16x32_bf16 v[100:103], a[64:67], v[68:71], v[100:103]
    buffer_load_dwordx4 v217, s[60:63], s27 offen lds
    ds_read2_b32 a[84:85], v157 offset0:32 offset1:33
    v_mfma_f32_16x16x32_bf16 v[104:107], a[68:71], v[68:71], v[104:107]
    ds_read2_b32 a[86:87], v157 offset0:34 offset1:35
    v_mfma_f32_16x16x32_bf16 v[108:111], a[72:75], v[68:71], v[108:111]
    ds_read_b128 v[68:71], v140 offset:704
    s_waitcnt lgkmcnt(15)
    v_mfma_f32_16x16x32_bf16 v[104:107], a[64:67], v[72:75], v[104:107]
    ds_read2_b32 a[88:89], v158 offset0:32 offset1:33
    v_mfma_f32_16x16x32_bf16 v[108:111], a[68:71], v[72:75], v[108:111]
    ds_read2_b32 a[90:91], v158 offset0:34 offset1:35
    ds_read_b128 v[72:75], v140 offset:1216
    v_mfma_f32_16x16x32_bf16 v[108:111], a[64:67], v[76:79], v[108:111]
    ds_read_b128 v[76:79], v140 offset:1728
    s_waitcnt lgkmcnt(15)
    v_mfma_f32_16x16x32_bf16 v[96:99], a[96:99], v[80:83], v[96:99]
    ds_read2_b32 a[92:93], v159 offset0:32 offset1:33
    v_mfma_f32_16x16x32_bf16 v[100:103], a[100:103], v[80:83], v[100:103]
    ds_read2_b32 a[94:95], v159 offset0:34 offset1:35
    v_mfma_f32_16x16x32_bf16 v[104:107], a[104:107], v[80:83], v[104:107]
    ds_read2_b32 a[112:113], v156 offset0:48 offset1:49
    v_mfma_f32_16x16x32_bf16 v[108:111], a[108:111], v[80:83], v[108:111]
    ds_read2_b32 a[114:115], v156 offset0:50 offset1:51
    ds_read_b128 v[80:83], v140 offset:2240
    v_mfma_f32_16x16x32_bf16 v[100:103], a[96:99], v[84:87], v[100:103]
    s_add_u32 m0, s81, 0
    ds_read2_b32 a[116:117], v157 offset0:48 offset1:49
    v_mfma_f32_16x16x32_bf16 v[104:107], a[100:103], v[84:87], v[104:107]
    buffer_load_dwordx4 v218, s[60:63], s27 offen lds
    ds_read2_b32 a[118:119], v157 offset0:50 offset1:51
    v_mfma_f32_16x16x32_bf16 v[108:111], a[104:107], v[84:87], v[108:111]
    ds_read_b128 v[84:87], v140 offset:2752
    s_waitcnt lgkmcnt(15)
    v_mfma_f32_16x16x32_bf16 v[104:107], a[96:99], v[88:91], v[104:107]
    ds_read2_b32 a[120:121], v158 offset0:48 offset1:49
    v_mfma_f32_16x16x32_bf16 v[108:111], a[100:103], v[88:91], v[108:111]
    ds_read2_b32 a[122:123], v158 offset0:50 offset1:51
    ds_read_b128 v[88:91], v140 offset:3264
    v_mfma_f32_16x16x32_bf16 v[108:111], a[96:99], v[92:95], v[108:111]
    ds_read_b128 v[92:95], v140 offset:3776
    s_waitcnt lgkmcnt(15)
    v_mfma_f32_16x16x32_bf16 v[112:115], a[16:19], v[64:67], 0
    ds_read2_b32 a[124:125], v159 offset0:48 offset1:49
    v_mfma_f32_16x16x32_bf16 v[116:119], a[20:23], v[64:67], 0
    ds_read2_b32 a[126:127], v159 offset0:50 offset1:51
    v_mfma_f32_16x16x32_bf16 v[120:123], a[24:27], v[64:67], 0
    ds_write_b128 v142, v[96:99] offset:0
    v_mfma_f32_16x16x32_bf16 v[124:127], a[28:31], v[64:67], 0
    ds_read_b128 v[64:67], v140 offset:128
    v_mfma_f32_16x16x32_bf16 v[112:115], a[12:15], v[68:71], v[112:115]
    ds_write_b128 v142, v[100:103] offset:1024
    v_mfma_f32_16x16x32_bf16 v[116:119], a[16:19], v[68:71], v[116:119]
    s_add_u32 m0, s0, s82
    v_mfma_f32_16x16x32_bf16 v[120:123], a[20:23], v[68:71], v[120:123]
    ds_write_b128 v142, v[104:107] offset:2048
    v_mfma_f32_16x16x32_bf16 v[124:127], a[24:27], v[68:71], v[124:127]
    ds_read_b128 v[68:71], v140 offset:640
    s_waitcnt lgkmcnt(15)
    v_mfma_f32_16x16x32_bf16 v[112:115], a[8:11], v[72:75], v[112:115]
    ds_write_b128 v142, v[108:111] offset:3072
    v_mfma_f32_16x16x32_bf16 v[116:119], a[12:15], v[72:75], v[116:119]
    ds_read_b64 v[32:33], v141 offset:0
    ds_read_b64 v[34:35], v141 offset:4608
    v_mfma_f32_16x16x32_bf16 v[120:123], a[16:19], v[72:75], v[120:123]
    buffer_load_dwordx4 v212, s[64:67], s27 offen lds
    v_mfma_f32_16x16x32_bf16 v[124:127], a[20:23], v[72:75], v[124:127]
    ds_read_b128 v[72:75], v140 offset:1152
    v_mfma_f32_16x16x32_bf16 v[112:115], a[4:7], v[76:79], v[112:115]
    v_mfma_f32_16x16x32_bf16 v[116:119], a[8:11], v[76:79], v[116:119]
    v_mfma_f32_16x16x32_bf16 v[120:123], a[12:15], v[76:79], v[120:123]
    v_mfma_f32_16x16x32_bf16 v[124:127], a[16:19], v[76:79], v[124:127]
    ds_read_b128 v[76:79], v140 offset:1664
    s_waitcnt lgkmcnt(15)
    v_mfma_f32_16x16x32_bf16 v[112:115], a[0:3], v[80:83], v[112:115]
    s_waitcnt lgkmcnt(0)
    s_barrier
    v_mfma_f32_16x16x32_bf16 v[116:119], a[4:7], v[80:83], v[116:119]
    ds_read_b128 v[160:163], v143 offset:0
    ds_read_b128 v[164:167], v143 offset:4096
    v_mfma_f32_16x16x32_bf16 v[120:123], a[8:11], v[80:83], v[120:123]
    ds_read_b128 v[168:171], v143 offset:8192
    ds_read_b128 v[172:175], v143 offset:12288
    v_mfma_f32_16x16x32_bf16 v[124:127], a[12:15], v[80:83], v[124:127]
    s_add_u32 m0, s1, s82
    ds_read_b128 v[80:83], v140 offset:2176
    v_mfma_f32_16x16x32_bf16 v[116:119], a[0:3], v[84:87], v[116:119]
    buffer_load_dwordx4 v213, s[64:67], s27 offen lds
    v_mfma_f32_16x16x32_bf16 v[120:123], a[4:7], v[84:87], v[120:123]
    v_mfma_f32_16x16x32_bf16 v[124:127], a[8:11], v[84:87], v[124:127]
    ds_read_b128 v[84:87], v140 offset:2688
    v_mfma_f32_16x16x32_bf16 v[120:123], a[0:3], v[88:91], v[120:123]
    v_mfma_f32_16x16x32_bf16 v[124:127], a[4:7], v[88:91], v[124:127]
    ds_read_b128 v[88:91], v140 offset:3200
    v_mfma_f32_16x16x32_bf16 v[124:127], a[0:3], v[92:95], v[124:127]
    ds_read_b128 v[92:95], v140 offset:3712
    v_mfma_f32_16x16x32_bf16 v[112:115], a[48:51], v[64:67], v[112:115]
    s_waitcnt lgkmcnt(4)
    v_add_f32 v160, v160, v164
    v_mfma_f32_16x16x32_bf16 v[116:119], a[52:55], v[64:67], v[116:119]
    v_add_f32 v161, v161, v165
    v_add_f32 v162, v162, v166
    v_mfma_f32_16x16x32_bf16 v[120:123], a[56:59], v[64:67], v[120:123]
    v_add_f32 v163, v163, v167
    v_add_f32 v168, v168, v172
    v_mfma_f32_16x16x32_bf16 v[124:127], a[60:63], v[64:67], v[124:127]
    v_add_f32 v169, v169, v173
    ds_read_b128 v[64:67], v140 offset:64
    v_mfma_f32_16x16x32_bf16 v[112:115], a[44:47], v[68:71], v[112:115]
    v_add_f32 v170, v170, v174
    v_add_f32 v171, v171, v175
    v_mfma_f32_16x16x32_bf16 v[116:119], a[48:51], v[68:71], v[116:119]
    v_dot2_f32_bf16 v160, v33, s29, v160
    v_dot2_f32_bf16 v168, v35, s31, v168
    v_dot2_f32_bf16 v161, v33, s28, v161
    v_dot2_f32_bf16 v169, v35, s30, v169
    v_dot2_f32_bf16 v162, v32, s29, v162
    v_dot2_f32_bf16 v170, v34, s31, v170
    v_dot2_f32_bf16 v163, v32, s28, v163
    v_dot2_f32_bf16 v171, v34, s30, v171
    v_mfma_f32_16x16x32_bf16 v[120:123], a[52:55], v[68:71], v[120:123]
    v_cvt_pk_bf16_f32 v164, v160, v168
    v_cvt_pk_bf16_f32 v165, v161, v169
    v_mfma_f32_16x16x32_bf16 v[124:127], a[56:59], v[68:71], v[124:127]
    ds_read_b128 v[68:71], v140 offset:576
    v_mfma_f32_16x16x32_bf16 v[112:115], a[40:43], v[72:75], v[112:115]
    v_cvt_pk_bf16_f32 v166, v162, v170
    v_cvt_pk_bf16_f32 v167, v163, v171
    v_mfma_f32_16x16x32_bf16 v[116:119], a[44:47], v[72:75], v[116:119]
    buffer_store_dwordx4 v[164:167], v144, s[76:79], s47 offen sc1
    s_add_u32 m0, s34, s82
    v_mfma_f32_16x16x32_bf16 v[120:123], a[48:51], v[72:75], v[120:123]
    buffer_load_dwordx4 v214, s[64:67], s27 offen lds
    v_mfma_f32_16x16x32_bf16 v[124:127], a[52:55], v[72:75], v[124:127]
    ds_read_b128 v[72:75], v140 offset:1088
    v_mfma_f32_16x16x32_bf16 v[112:115], a[36:39], v[76:79], v[112:115]
    s_add_u32 m0, s35, s82
    v_mfma_f32_16x16x32_bf16 v[116:119], a[40:43], v[76:79], v[116:119]
    buffer_load_dwordx4 v215, s[64:67], s27 offen lds
    v_mfma_f32_16x16x32_bf16 v[120:123], a[44:47], v[76:79], v[120:123]
    v_mfma_f32_16x16x32_bf16 v[124:127], a[48:51], v[76:79], v[124:127]
    ds_read_b128 v[76:79], v140 offset:1600
    s_waitcnt lgkmcnt(6)
    v_mfma_f32_16x16x32_bf16 v[112:115], a[32:35], v[80:83], v[112:115]
    v_mfma_f32_16x16x32_bf16 v[116:119], a[36:39], v[80:83], v[116:119]
    v_mfma_f32_16x16x32_bf16 v[120:123], a[40:43], v[80:83], v[120:123]
    v_mfma_f32_16x16x32_bf16 v[124:127], a[44:47], v[80:83], v[124:127]
    ds_read_b128 v[80:83], v140 offset:2112
    v_mfma_f32_16x16x32_bf16 v[116:119], a[32:35], v[84:87], v[116:119]
    v_mfma_f32_16x16x32_bf16 v[120:123], a[36:39], v[84:87], v[120:123]
    v_mfma_f32_16x16x32_bf16 v[124:127], a[40:43], v[84:87], v[124:127]
    ds_read_b128 v[84:87], v140 offset:2624
    s_waitcnt lgkmcnt(6)
    v_mfma_f32_16x16x32_bf16 v[120:123], a[32:35], v[88:91], v[120:123]
    s_add_u32 m0, s54, s82
    v_mfma_f32_16x16x32_bf16 v[124:127], a[36:39], v[88:91], v[124:127]
    buffer_load_dwordx4 v216, s[64:67], s27 offen lds
    ds_read_b128 v[88:91], v140 offset:3136
    v_mfma_f32_16x16x32_bf16 v[124:127], a[32:35], v[92:95], v[124:127]
    ds_read_b128 v[92:95], v140 offset:3648
    s_waitcnt lgkmcnt(6)
    v_mfma_f32_16x16x32_bf16 v[112:115], a[80:83], v[64:67], v[112:115]
    v_mfma_f32_16x16x32_bf16 v[116:119], a[84:87], v[64:67], v[116:119]
    v_mfma_f32_16x16x32_bf16 v[120:123], a[88:91], v[64:67], v[120:123]
    v_mfma_f32_16x16x32_bf16 v[124:127], a[92:95], v[64:67], v[124:127]
    ds_read_b128 v[64:67], v140 offset:0
    v_mfma_f32_16x16x32_bf16 v[112:115], a[76:79], v[68:71], v[112:115]
    v_mfma_f32_16x16x32_bf16 v[116:119], a[80:83], v[68:71], v[116:119]
    v_mfma_f32_16x16x32_bf16 v[120:123], a[84:87], v[68:71], v[120:123]
    v_mfma_f32_16x16x32_bf16 v[124:127], a[88:91], v[68:71], v[124:127]
    ds_read_b128 v[68:71], v140 offset:512
    s_waitcnt lgkmcnt(6)
    v_mfma_f32_16x16x32_bf16 v[112:115], a[72:75], v[72:75], v[112:115]
    s_add_u32 m0, s80, s82
    v_mfma_f32_16x16x32_bf16 v[116:119], a[76:79], v[72:75], v[116:119]
    buffer_load_dwordx4 v217, s[64:67], s27 offen lds
    v_mfma_f32_16x16x32_bf16 v[120:123], a[80:83], v[72:75], v[120:123]
    v_mfma_f32_16x16x32_bf16 v[124:127], a[84:87], v[72:75], v[124:127]
    ds_read_b128 v[72:75], v140 offset:1024
    v_mfma_f32_16x16x32_bf16 v[112:115], a[68:71], v[76:79], v[112:115]
    v_mfma_f32_16x16x32_bf16 v[116:119], a[72:75], v[76:79], v[116:119]
    v_mfma_f32_16x16x32_bf16 v[120:123], a[76:79], v[76:79], v[120:123]
    v_mfma_f32_16x16x32_bf16 v[124:127], a[80:83], v[76:79], v[124:127]
    ds_read_b128 v[76:79], v140 offset:1536
    s_waitcnt lgkmcnt(6)
    v_mfma_f32_16x16x32_bf16 v[112:115], a[64:67], v[80:83], v[112:115]
    v_mfma_f32_16x16x32_bf16 v[116:119], a[68:71], v[80:83], v[116:119]
    v_mfma_f32_16x16x32_bf16 v[120:123], a[72:75], v[80:83], v[120:123]
    v_mfma_f32_16x16x32_bf16 v[124:127], a[76:79], v[80:83], v[124:127]
    s_add_u32 m0, s81, s82
    ds_read_b128 v[80:83], v140 offset:2048
    v_mfma_f32_16x16x32_bf16 v[116:119], a[64:67], v[84:87], v[116:119]
    buffer_load_dwordx4 v218, s[64:67], s27 offen lds
    v_mfma_f32_16x16x32_bf16 v[120:123], a[68:71], v[84:87], v[120:123]
    v_mfma_f32_16x16x32_bf16 v[124:127], a[72:75], v[84:87], v[124:127]
    ds_read_b128 v[84:87], v140 offset:2560
    s_waitcnt lgkmcnt(6)
    v_mfma_f32_16x16x32_bf16 v[120:123], a[64:67], v[88:91], v[120:123]
    v_mfma_f32_16x16x32_bf16 v[124:127], a[68:71], v[88:91], v[124:127]
    ds_read_b128 v[88:91], v140 offset:3072
    v_mfma_f32_16x16x32_bf16 v[124:127], a[64:67], v[92:95], v[124:127]
    ds_read_b128 v[92:95], v140 offset:3584
    s_waitcnt lgkmcnt(6)
    v_mfma_f32_16x16x32_bf16 v[112:115], a[112:115], v[64:67], v[112:115]
    v_mfma_f32_16x16x32_bf16 v[116:119], a[116:119], v[64:67], v[116:119]
    v_mfma_f32_16x16x32_bf16 v[120:123], a[120:123], v[64:67], v[120:123]
    v_mfma_f32_16x16x32_bf16 v[124:127], a[124:127], v[64:67], v[124:127]
    v_mfma_f32_16x16x32_bf16 v[112:115], a[108:111], v[68:71], v[112:115]
    v_mfma_f32_16x16x32_bf16 v[116:119], a[112:115], v[68:71], v[116:119]
    v_mfma_f32_16x16x32_bf16 v[120:123], a[116:119], v[68:71], v[120:123]
    v_mfma_f32_16x16x32_bf16 v[124:127], a[120:123], v[68:71], v[124:127]
    s_waitcnt lgkmcnt(4)
    v_mfma_f32_16x16x32_bf16 v[112:115], a[104:107], v[72:75], v[112:115]
    v_mfma_f32_16x16x32_bf16 v[116:119], a[108:111], v[72:75], v[116:119]
    v_mfma_f32_16x16x32_bf16 v[120:123], a[112:115], v[72:75], v[120:123]
    v_mfma_f32_16x16x32_bf16 v[124:127], a[116:119], v[72:75], v[124:127]
    v_mfma_f32_16x16x32_bf16 v[112:115], a[100:103], v[76:79], v[112:115]
    v_mfma_f32_16x16x32_bf16 v[116:119], a[104:107], v[76:79], v[116:119]
    v_mfma_f32_16x16x32_bf16 v[120:123], a[108:111], v[76:79], v[120:123]
    v_mfma_f32_16x16x32_bf16 v[124:127], a[112:115], v[76:79], v[124:127]
    s_waitcnt lgkmcnt(2)
    v_mfma_f32_16x16x32_bf16 v[112:115], a[96:99], v[80:83], v[112:115]
    v_mfma_f32_16x16x32_bf16 v[116:119], a[100:103], v[80:83], v[116:119]
    v_mfma_f32_16x16x32_bf16 v[120:123], a[104:107], v[80:83], v[120:123]
    v_mfma_f32_16x16x32_bf16 v[124:127], a[108:111], v[80:83], v[124:127]
    v_mfma_f32_16x16x32_bf16 v[116:119], a[96:99], v[84:87], v[116:119]
    v_mfma_f32_16x16x32_bf16 v[120:123], a[100:103], v[84:87], v[120:123]
    v_mfma_f32_16x16x32_bf16 v[124:127], a[104:107], v[84:87], v[124:127]
    s_waitcnt lgkmcnt(0)
    v_mfma_f32_16x16x32_bf16 v[120:123], a[96:99], v[88:91], v[120:123]
    v_mfma_f32_16x16x32_bf16 v[124:127], a[100:103], v[88:91], v[124:127]
    v_mfma_f32_16x16x32_bf16 v[124:127], a[96:99], v[92:95], v[124:127]
    ds_read_b64 v[36:37], v141 offset:2048
    ds_read_b64 v[38:39], v141 offset:6656
    ds_write_b128 v142, v[112:115] offset:16384
    ds_write_b128 v142, v[116:119] offset:17408
    s_nop 1
    ds_write_b128 v142, v[120:123] offset:18432
    s_nop 0
    ds_write_b128 v142, v[124:127] offset:19456
    s_waitcnt lgkmcnt(0)
    s_barrier
    ds_read_b128 v[176:179], v143 offset:16384
    ds_read_b128 v[180:183], v143 offset:20480
    ds_read_b128 v[184:187], v143 offset:24576
    ds_read_b128 v[188:191], v143 offset:28672
    s_waitcnt lgkmcnt(0)
    v_pk_add_f32 v[176:177], v[176:177], v[180:181]
    v_pk_add_f32 v[178:179], v[178:179], v[182:183]
    v_pk_add_f32 v[184:185], v[184:185], v[188:189]
    v_pk_add_f32 v[186:187], v[186:187], v[190:191]
    v_dot2_f32_bf16 v176, v37, s29, v176
    v_dot2_f32_bf16 v184, v39, s31, v184
    v_dot2_f32_bf16 v177, v37, s28, v177
    v_dot2_f32_bf16 v185, v39, s30, v185
    v_dot2_f32_bf16 v178, v36, s29, v178
    v_dot2_f32_bf16 v186, v38, s31, v186
    v_dot2_f32_bf16 v179, v36, s28, v179
    v_dot2_f32_bf16 v187, v38, s30, v187
    v_cvt_pk_bf16_f32 v180, v176, v184
    v_cvt_pk_bf16_f32 v181, v177, v185
    v_cvt_pk_bf16_f32 v182, v178, v186
    v_cvt_pk_bf16_f32 v183, v179, v187
    buffer_store_dwordx4 v[180:183], v145, s[76:79], s47 offen sc1
    s_waitcnt vmcnt(13)
    ds_read_b64_tr_b16 a[128:129], v194 offset:0
    ds_read_b64_tr_b16 a[130:131], v194 offset:512
    ds_read_b64_tr_b16 a[132:133], v194 offset:32
    ds_read_b64_tr_b16 a[134:135], v194 offset:544
    ds_read_b64_tr_b16 a[136:137], v194 offset:64
    ds_read_b64_tr_b16 a[138:139], v194 offset:576
    ds_read_b64_tr_b16 a[140:141], v194 offset:96
    ds_read_b64_tr_b16 a[142:143], v194 offset:608
    s_waitcnt lgkmcnt(6)
    buffer_store_dwordx4 a[128:131], v195, s[76:79], 0 offen offset:0 sc1
    s_waitcnt lgkmcnt(4)
    buffer_store_dwordx4 a[132:135], v195, s[76:79], 0 offen offset:1024 sc1
    s_waitcnt lgkmcnt(2)
    buffer_store_dwordx4 a[136:139], v195, s[76:79], 0 offen offset:2048 sc1
    s_waitcnt lgkmcnt(0)
    buffer_store_dwordx4 a[140:143], v195, s[76:79], 0 offen offset:3072 sc1
    s_lshl_b32 s12, s5, 2
    s_add_u32 s12, s12, s6
    s_lshl_b32 s20, s4, 18
    s_lshl_b32 s21, s4, 12
    s_lshr_b32 s22, s5, 3
    s_and_b32 s23, s5, 7
    s_lshl_b32 s13, s12, 2
    s_add_u32 s13, s13, s21
    s_add_u32 s95, s13, 69632
    s_lshl_b32 s13, s6, 7
    s_add_u32 s13, s13, s21
    s_add_u32 s94, s13, 69632
    s_lshl_b32 s14, s5, 2
    s_add_u32 s13, s13, s14
    s_add_u32 s97, s13, 102400
    s_lshl_b32 s13, s22, 7
    s_lshl_b32 s14, s6, 5
    s_add_u32 s13, s13, s14
    s_add_u32 s13, s13, s21
    s_add_u32 s96, s13, 102400
    s_lshl_b32 s14, s23, 2
    s_add_u32 s13, s13, s14
    s_add_u32 s99, s13, 135168
    s_lshr_b32 s13, s5, 1
    s_lshl_b32 s13, s13, 5
    s_add_u32 s13, s13, s21
    s_add_u32 s98, s13, 135168
    s_lshr_b32 s13, s12, 5
    s_lshl_b32 s13, s13, 15
    s_bfe_u32 s14, s12, 0x10004
    s_lshl_b32 s14, s14, 10
    s_and_b32 s15, s12, 12
    s_lshl_b32 s15, s15, 4
    s_add_u32 s13, s13, s14
    s_add_u32 s13, s13, s15
    s_add_u32 s13, s13, s20
    s_lshl_b32 s14, s6, 13
    s_add_u32 s14, s14, 1048576
    s_add_u32 s13, s13, s14
    v_lshrrev_b32 v5, 4, v1
    v_lshlrev_b32 v5, 11, v5
    v_bfe_u32 v12, v1, 2, 2
    v_lshl_add_u32 v12, v12, 8, v5
    v_and_b32 v5, 3, v1
    v_lshl_add_u32 v12, v5, 4, v12
    v_add_u32 v12, s13, v12
    s_lshl_b32 s13, s6, 15
    s_add_u32 s13, s13, s20
    s_add_u32 s13, s13, 1048576
    v_add_u32 v6, s13, v2
    v_add_u32 v7, 0x20000, v6
    v_add_u32 v19, 57344, v2
    v_lshrrev_b32 v5, 4, v1
    v_and_b32 v23, 15, v1
    v_lshlrev_b32 v22, 9, v5
    v_lshl_add_u32 v22, v23, 4, v22
    s_mul_i32 s16, s4, 917504
    s_add_u32 s16, s16, 7340032
    s_mul_i32 s13, s6, 114688
    s_mul_i32 s14, s5, 3584
    s_add_u32 s13, s13, s14
    s_add_u32 s13, s13, s16
    v_add_u32 v10, s13, v22
    s_mul_i32 s13, s22, 114688
    s_mul_i32 s14, s6, 28672
    s_add_u32 s13, s13, s14
    s_add_u32 s13, s13, s16
    v_add_u32 v8, s13, v22
    v_add_u32 v9, 458752, v8
    v_cmp_gt_u32 vcc, 48, v1
    v_add_u32 v11, 2048, v10
    v_mov_b32 v22, 0x80000000
    v_mul_u32_u24 v15, 272, v23
    v_cndmask_b32 v11, v22, v11, vcc
    v_lshl_add_u32 v15, v5, 4, v15
    s_mul_i32 s13, s6, 8704
    s_add_u32 s13, s13, 114688
    v_add_u32 v15, s13, v15
    v_lshrrev_b32 v5, 3, v1
    v_mul_u32_u24 v16, 272, v5
    v_lshl_add_u32 v16, v18, 3, v16
    s_mul_i32 s13, s6, 2176
    s_add_u32 s13, s13, 114688
    v_add_u32 v16, s13, v16
    s_lshl_b32 s13, s22, 5
    s_lshl_b32 s14, s6, 3
    s_add_u32 s13, s13, s14
    v_add_u32 v5, s13, v5
    s_lshl_b32 s14, s23, 7
    s_lshl_b32 s13, s4, 17
    s_add_u32 s14, s14, s13
    v_lshl_add_u32 v22, v18, 2, s14
    v_lshl_add_u32 v14, v5, 10, v22
    s_lshr_b32 s13, s23, 2
    s_lshl_b32 s13, s13, 13
    s_and_b32 s14, s23, 3
    s_lshl_b32 s14, s14, 7
    s_add_u32 s13, s13, s14
    s_lshl_b32 s14, s4, 9
    s_add_u32 s13, s13, s14
    s_add_u32 s13, s13, 3145728
    v_lshl_add_u32 v13, v18, 2, s13
    v_lshl_add_u32 v13, v5, 14, v13
    s_mov_b32 s55, 0x100000
    s_lshl_b32 s13, s12, 14
    s_add_u32 s13, s13, s14
    s_add_u32 s100, s13, 3145728
    s_add_u32 s101, s13, 3149824
    v_lshrrev_b32 v5, 5, v1
    v_lshlrev_b32 v5, 13, v5
    v_lshl_add_u32 v0, v17, 2, v5
    s_waitcnt vmcnt(4)
    buffer_store_dword v4, v3, s[76:79], s48 offen offset:0 sc1
    s_waitcnt vmcnt(1)
    buffer_store_dword v4, v3, s[76:79], s51 offen offset:0 sc1
    s_barrier
    s_lshl_b32 s12, s4, 7
    s_lshl_b32 s13, s5, 2
    s_add_u32 s12, s12, s13
    s_add_u32 s12, s12, s6
    s_lshl_b32 s12, s12, 10
    s_mov_b32 s22, s12
    s_add_u32 s23, s12, 0x100000
    buffer_load_dwordx4 v[204:207], v2, s[56:59], s22 offen
    buffer_load_dwordx4 v[208:211], v2, s[56:59], s23 offen
    s_add_u32 s27, s27, 917504
    s_add_u32 m0, s0, 57344
    s_nop 0
    buffer_load_dwordx4 v212, s[60:63], s27 offen lds
    s_add_u32 m0, s1, 57344
    s_nop 0
    buffer_load_dwordx4 v213, s[60:63], s27 offen lds
    s_add_u32 m0, s34, 57344
    s_nop 0
    buffer_load_dwordx4 v214, s[60:63], s27 offen lds
    s_add_u32 m0, s35, 57344
    s_nop 0
    buffer_load_dwordx4 v215, s[60:63], s27 offen lds
    v_lshrrev_b32 v5, 4, v1
    v_bfe_u32 v222, v1, 2, 2
    v_lshl_add_u32 v222, v5, 3, v222
    v_mul_u32_u24 v222, 112, v222
    v_add_u32 v222, s3, v222
    v_and_b32 v224, 3, v1
    v_bfe_u32 v225, v1, 1, 1
    v_mul_u32_u24 v225, 7168, v225
    v_and_b32 v22, 1, v1
    v_lshl_add_u32 v225, v22, 3, v225
    v_add_u32 v223, v222, v225
    v_lshl_add_u32 v222, v224, 3, v222
    v_add_u32 v224, s3, v2
    v_bfe_u32 v225, v1, 1, 2
    v_lshlrev_b32 v225, 2, v225
    v_bfe_u32 v23, v1, 3, 1
    v_lshl_add_u32 v225, v23, 1, v225
    v_add_u32 v225, v225, v22
    v_lshl_add_u32 v225, v5, 4, v225
    v_lshlrev_b32 v225, 4, v225
    v_add_u32 v225, s3, v225
    s_and_b32 s12, s5, 7
    s_lshl_b32 s12, s12, 2
    s_add_u32 s12, s12, s6
    s_mul_i32 s53, s12, 56
    s_add_u32 s53, s53, 253952
    s_mul_i32 s12, s12, 57344
    s_add_u32 s12, s12, 14680064
    v_add_u32 v230, s12, v2
    v_add_u32 v231, 32768, v230
    v_min_u32 v226, 13, v1
    v_mul_u32_u24 v226, 4, v226
    s_add_u32 s20, s50, 4096
    ds_read_b64_tr_b16 a[128:129], v222 offset:0
    ds_read_b64_tr_b16 a[130:131], v222 offset:448
    ds_read_b64_tr_b16 a[132:133], v222 offset:7168
    ds_read_b64_tr_b16 a[134:135], v222 offset:7616
    ds_read_b64_tr_b16 a[136:137], v222 offset:32
    ds_read_b64_tr_b16 a[138:139], v222 offset:480
    ds_read_b64_tr_b16 a[140:141], v222 offset:7200
    ds_read_b64_tr_b16 a[142:143], v222 offset:7648
    ds_read_b64_tr_b16 a[144:145], v222 offset:64
    ds_read_b64_tr_b16 a[146:147], v222 offset:512
    ds_read_b64_tr_b16 a[148:149], v222 offset:7232
    ds_read_b64_tr_b16 a[150:151], v222 offset:7680
    ds_read_b64_tr_b16 a[152:153], v223 offset:96
    ds_read_b64_tr_b16 a[154:155], v223 offset:544
    ds_read_b64_tr_b16 a[156:157], v222 offset:3584
    ds_read_b64_tr_b16 a[158:159], v222 offset:4032
    ds_read_b64_tr_b16 a[160:161], v222 offset:10752
    ds_read_b64_tr_b16 a[162:163], v222 offset:11200
    ds_read_b64_tr_b16 a[164:165], v222 offset:3616
    ds_read_b64_tr_b16 a[166:167], v222 offset:4064
    ds_read_b64_tr_b16 a[168:169], v222 offset:10784
    ds_read_b64_tr_b16 a[170:171], v222 offset:11232
    ds_read_b64_tr_b16 a[172:173], v222 offset:3648
    ds_read_b64_tr_b16 a[174:175], v222 offset:4096
    ds_read_b64_tr_b16 a[176:177], v222 offset:10816
    ds_read_b64_tr_b16 a[178:179], v222 offset:11264
    ds_read_b64_tr_b16 a[180:181], v223 offset:3680
    ds_read_b64_tr_b16 a[182:183], v223 offset:4128
    s_waitcnt lgkmcnt(0)
    ds_write_b128 v224, a[128:131] offset:0
    ds_write_b128 v224, a[132:135] offset:1024
    ds_write_b128 v224, a[136:139] offset:2048
    ds_write_b128 v224, a[140:143] offset:3072
    ds_write_b128 v224, a[144:147] offset:4096
    ds_write_b128 v224, a[148:151] offset:5120
    ds_write_b128 v225, a[152:155] offset:6144
    ds_write_b128 v224, a[156:159] offset:7168
    ds_write_b128 v224, a[160:163] offset:8192
    ds_write_b128 v224, a[164:167] offset:9216
    ds_write_b128 v224, a[168:171] offset:10240
    ds_write_b128 v224, a[172:175] offset:11264
    ds_write_b128 v224, a[176:179] offset:12288
    ds_write_b128 v225, a[180:183] offset:13312
    s_waitcnt vmcnt(4)
    v_lshlrev_b32 v240, 16, v204
    v_and_b32 v241, 0xffff0000, v204
    v_lshlrev_b32 v242, 16, v205
    v_and_b32 v243, 0xffff0000, v205
    v_lshlrev_b32 v244, 16, v206
    v_and_b32 v245, 0xffff0000, v206
    v_lshlrev_b32 v246, 16, v207
    v_and_b32 v247, 0xffff0000, v207
    v_lshlrev_b32 v248, 16, v208
    v_and_b32 v249, 0xffff0000, v208
    v_lshlrev_b32 v250, 16, v209
    v_and_b32 v251, 0xffff0000, v209
    v_lshlrev_b32 v252, 16, v210
    v_and_b32 v253, 0xffff0000, v210
    v_lshlrev_b32 v254, 16, v211
    v_and_b32 v255, 0xffff0000, v211
    v_pk_add_f32 v[128:129], v[240:241], v[242:243]
    v_pk_mul_f32 v[130:131], v[240:241], v[240:241]
    v_pk_add_f32 v[132:133], v[244:245], v[246:247]
    v_pk_fma_f32 v[130:131], v[242:243], v[242:243], v[130:131]
    v_pk_fma_f32 v[130:131], v[244:245], v[244:245], v[130:131]
    v_pk_fma_f32 v[130:131], v[246:247], v[246:247], v[130:131]
    v_pk_add_f32 v[128:129], v[128:129], v[132:133]
    v_add_f32 v130, v130, v131
    v_add_f32 v128, v128, v129
    v_pk_add_f32 v[134:135], v[248:249], v[250:251]
    v_pk_mul_f32 v[136:137], v[248:249], v[248:249]
    v_pk_add_f32 v[138:139], v[252:253], v[254:255]
    v_pk_fma_f32 v[136:137], v[250:251], v[250:251], v[136:137]
    v_pk_fma_f32 v[136:137], v[252:253], v[252:253], v[136:137]
    v_pk_fma_f32 v[136:137], v[254:255], v[254:255], v[136:137]
    v_pk_add_f32 v[134:135], v[134:135], v[138:139]
    v_add_f32 v136, v136, v137
    v_add_f32 v134, v134, v135
    v_add_f32_dpp v130, v130, v130 row_ror:8 row_mask:0xf bank_mask:0xf
    v_add_f32_dpp v128, v128, v128 row_ror:8 row_mask:0xf bank_mask:0xf
    v_add_f32_dpp v136, v136, v136 row_ror:8 row_mask:0xf bank_mask:0xf
    v_add_f32_dpp v134, v134, v134 row_ror:8 row_mask:0xf bank_mask:0xf
    v_add_f32_dpp v130, v130, v130 row_ror:4 row_mask:0xf bank_mask:0xf
    v_add_f32_dpp v128, v128, v128 row_ror:4 row_mask:0xf bank_mask:0xf
    v_add_f32_dpp v136, v136, v136 row_ror:4 row_mask:0xf bank_mask:0xf
    v_add_f32_dpp v134, v134, v134 row_ror:4 row_mask:0xf bank_mask:0xf
    v_add_f32_dpp v130, v130, v130 row_ror:2 row_mask:0xf bank_mask:0xf
    v_add_f32_dpp v128, v128, v128 row_ror:2 row_mask:0xf bank_mask:0xf
    v_add_f32_dpp v136, v136, v136 row_ror:2 row_mask:0xf bank_mask:0xf
    v_add_f32_dpp v134, v134, v134 row_ror:2 row_mask:0xf bank_mask:0xf
    v_add_f32_dpp v130, v130, v130 row_ror:1 row_mask:0xf bank_mask:0xf
    v_add_f32_dpp v128, v128, v128 row_ror:1 row_mask:0xf bank_mask:0xf
    v_add_f32_dpp v136, v136, v136 row_ror:1 row_mask:0xf bank_mask:0xf
    v_add_f32_dpp v134, v134, v134 row_ror:1 row_mask:0xf bank_mask:0xf
    v_add_f32_dpp v130, v130, v130 row_bcast:15 row_mask:0xa bank_mask:0xf
    v_add_f32_dpp v128, v128, v128 row_bcast:15 row_mask:0xa bank_mask:0xf
    v_add_f32_dpp v136, v136, v136 row_bcast:15 row_mask:0xa bank_mask:0xf
    v_add_f32_dpp v134, v134, v134 row_bcast:15 row_mask:0xa bank_mask:0xf
    v_add_f32_dpp v130, v130, v130 row_bcast:31 row_mask:0xc bank_mask:0xf
    v_add_f32_dpp v128, v128, v128 row_bcast:31 row_mask:0xc bank_mask:0xf
    v_add_f32_dpp v136, v136, v136 row_bcast:31 row_mask:0xc bank_mask:0xf
    v_add_f32_dpp v134, v134, v134 row_bcast:31 row_mask:0xc bank_mask:0xf
    v_mul_f32 v128, 0x3b000000, v128
    v_mul_f32 v130, 0x3b000000, v130
    v_fma_f32 v130, -v128, v128, v130
    v_max_f32 v130, 0, v130
    v_add_f32 v130, 0x3727c5ac, v130
    v_rsq_f32 v130, v130
    v_mul_f32 v134, 0x3b000000, v134
    v_mul_f32_e64 v128, -v128, v130
    v_readlane_b32 s36, v130, 63
    v_readlane_b32 s38, v128, 63
    v_mul_f32 v136, 0x3b000000, v136
    v_fma_f32 v136, -v134, v134, v136
    v_mov_b32 v132, s38
    v_max_f32 v136, 0, v136
    v_add_f32 v136, 0x3727c5ac, v136
    v_pk_fma_f32 v[40:41], v[240:241], s[36:37], v[132:133] op_sel_hi:[1,0,0]
    v_rsq_f32 v136, v136
    v_pk_fma_f32 v[42:43], v[242:243], s[36:37], v[132:133] op_sel_hi:[1,0,0]
    v_mul_f32_e64 v134, -v134, v136
    v_readlane_b32 s40, v136, 63
    v_readlane_b32 s42, v134, 63
    v_pk_fma_f32 v[44:45], v[244:245], s[36:37], v[132:133] op_sel_hi:[1,0,0]
    v_pk_fma_f32 v[46:47], v[246:247], s[36:37], v[132:133] op_sel_hi:[1,0,0]
    v_mov_b32 v138, s42
    v_pk_fma_f32 v[118:119], v[248:249], s[40:41], v[138:139] op_sel_hi:[1,0,0]
    v_pk_fma_f32 v[120:121], v[250:251], s[40:41], v[138:139] op_sel_hi:[1,0,0]
    v_pk_fma_f32 v[122:123], v[252:253], s[40:41], v[138:139] op_sel_hi:[1,0,0]
    v_pk_fma_f32 v[124:125], v[254:255], s[40:41], v[138:139] op_sel_hi:[1,0,0]
    s_mul_i32 s56, s6, 1088
    s_add_u32 s56, s56, 114688
    s_lshl_b32 s57, s6, 8
    s_add_u32 s57, s57, 114688
    v_bfe_u32 v101, v2, 4, 2
    v_mul_u32_u24 v101, 1088, v101
    v_lshrrev_b32 v100, 6, v2
    v_lshl_add_u32 v101, v100, 4, v101
    v_add_u32 v101, s57, v101
    v_add_u32 v100, s56, v2
    buffer_load_dword v5, v146, s[76:79], s49 offen offset:0 sc1
    s_waitcnt vmcnt(0)
    v_cmp_ne_u32 vcc, s7, v5
    s_cbranch_vccnz L11
L12:
    buffer_load_dwordx4 v[32:35], v147, s[76:79], s50 offen sc1
    buffer_load_dwordx4 v[36:39], v147, s[76:79], s20 offen sc1
    buffer_load_dword v229, v226, s[76:79], s53 offen offset:0 sc1
    s_barrier
    s_add_u32 m0, s54, 57344
    s_nop 0
    buffer_load_dwordx4 v216, s[60:63], s27 offen lds
    s_add_u32 m0, s80, 57344
    s_nop 0
    buffer_load_dwordx4 v217, s[60:63], s27 offen lds
    s_add_u32 m0, s81, 57344
    s_nop 0
    buffer_load_dwordx4 v218, s[60:63], s27 offen lds
    s_add_u32 m0, s0, s83
    s_nop 0
    buffer_load_dwordx4 v212, s[64:67], s27 offen lds
    s_add_u32 m0, s1, s83
    s_nop 0
    buffer_load_dwordx4 v213, s[64:67], s27 offen lds
    s_add_u32 m0, s34, s83
    s_nop 0
    buffer_load_dwordx4 v214, s[64:67], s27 offen lds
    s_waitcnt vmcnt(8)
    ds_write_b32 v148, v32 offset:0
    ds_write_b32 v148, v33 offset:1024
    ds_write_b32 v148, v34 offset:2048
    ds_write_b32 v148, v35 offset:3072
    s_waitcnt vmcnt(7)
    ds_write_b32 v148, v36 offset:4096
    ds_write_b32 v148, v37 offset:5120
    ds_write_b32 v148, v38 offset:6144
    ds_write_b32 v148, v39 offset:7168
    s_waitcnt lgkmcnt(0)
    s_barrier
    ds_read_b128 v[232:235], v149 offset:0
    ds_read_b128 v[236:239], v149 offset:4096
    s_waitcnt lgkmcnt(0)
    v_lshlrev_b32 v56, 16, v232
    v_and_b32 v57, 0xffff0000, v232
    v_lshlrev_b32 v58, 16, v233
    v_and_b32 v59, 0xffff0000, v233
    v_lshlrev_b32 v60, 16, v234
    v_and_b32 v61, 0xffff0000, v234
    v_lshlrev_b32 v62, 16, v235
    v_and_b32 v63, 0xffff0000, v235
    v_pk_fma_f32 v[240:241], v[40:41], v[56:57], v[240:241]
    v_pk_fma_f32 v[242:243], v[42:43], v[58:59], v[242:243]
    v_pk_fma_f32 v[244:245], v[44:45], v[60:61], v[244:245]
    v_pk_fma_f32 v[246:247], v[46:47], v[62:63], v[246:247]
    v_lshlrev_b32 v72, 16, v236
    v_and_b32 v73, 0xffff0000, v236
    v_lshlrev_b32 v74, 16, v237
    v_and_b32 v75, 0xffff0000, v237
    v_lshlrev_b32 v76, 16, v238
    v_and_b32 v77, 0xffff0000, v238
    v_lshlrev_b32 v78, 16, v239
    v_and_b32 v79, 0xffff0000, v239
    v_pk_fma_f32 v[248:249], v[118:119], v[72:73], v[248:249]
    v_pk_fma_f32 v[250:251], v[120:121], v[74:75], v[250:251]
    v_pk_fma_f32 v[252:253], v[122:123], v[76:77], v[252:253]
    v_pk_fma_f32 v[254:255], v[124:125], v[78:79], v[254:255]
    v_pk_add_f32 v[88:89], v[240:241], v[242:243]
    v_pk_mul_f32 v[90:91], v[240:241], v[240:241]
    v_pk_add_f32 v[92:93], v[244:245], v[246:247]
    v_pk_fma_f32 v[90:91], v[242:243], v[242:243], v[90:91]
    v_pk_fma_f32 v[90:91], v[244:245], v[244:245], v[90:91]
    v_pk_fma_f32 v[90:91], v[246:247], v[246:247], v[90:91]
    v_pk_add_f32 v[88:89], v[88:89], v[92:93]
    v_add_f32 v90, v90, v91
    v_add_f32 v88, v88, v89
    v_pk_add_f32 v[94:95], v[248:249], v[250:251]
    v_pk_mul_f32 v[96:97], v[248:249], v[248:249]
    v_pk_add_f32 v[98:99], v[252:253], v[254:255]
    v_pk_fma_f32 v[96:97], v[250:251], v[250:251], v[96:97]
    v_pk_fma_f32 v[96:97], v[252:253], v[252:253], v[96:97]
    v_pk_fma_f32 v[96:97], v[254:255], v[254:255], v[96:97]
    v_pk_add_f32 v[94:95], v[94:95], v[98:99]
    v_add_f32 v96, v96, v97
    v_add_f32 v94, v94, v95
    v_add_f32_dpp v90, v90, v90 row_ror:8 row_mask:0xf bank_mask:0xf
    v_add_f32_dpp v88, v88, v88 row_ror:8 row_mask:0xf bank_mask:0xf
    v_add_f32_dpp v96, v96, v96 row_ror:8 row_mask:0xf bank_mask:0xf
    v_add_f32_dpp v94, v94, v94 row_ror:8 row_mask:0xf bank_mask:0xf
    v_add_f32_dpp v90, v90, v90 row_ror:4 row_mask:0xf bank_mask:0xf
    v_add_f32_dpp v88, v88, v88 row_ror:4 row_mask:0xf bank_mask:0xf
    v_add_f32_dpp v96, v96, v96 row_ror:4 row_mask:0xf bank_mask:0xf
    v_add_f32_dpp v94, v94, v94 row_ror:4 row_mask:0xf bank_mask:0xf
    v_add_f32_dpp v90, v90, v90 row_ror:2 row_mask:0xf bank_mask:0xf
    v_add_f32_dpp v88, v88, v88 row_ror:2 row_mask:0xf bank_mask:0xf
    v_add_f32_dpp v96, v96, v96 row_ror:2 row_mask:0xf bank_mask:0xf
    v_add_f32_dpp v94, v94, v94 row_ror:2 row_mask:0xf bank_mask:0xf
    v_add_f32_dpp v90, v90, v90 row_ror:1 row_mask:0xf bank_mask:0xf
    v_add_f32_dpp v88, v88, v88 row_ror:1 row_mask:0xf bank_mask:0xf
    v_add_f32_dpp v96, v96, v96 row_ror:1 row_mask:0xf bank_mask:0xf
    v_add_f32_dpp v94, v94, v94 row_ror:1 row_mask:0xf bank_mask:0xf
    v_add_f32_dpp v90, v90, v90 row_bcast:15 row_mask:0xa bank_mask:0xf
    v_add_f32_dpp v88, v88, v88 row_bcast:15 row_mask:0xa bank_mask:0xf
    v_add_f32_dpp v96, v96, v96 row_bcast:15 row_mask:0xa bank_mask:0xf
    v_add_f32_dpp v94, v94, v94 row_bcast:15 row_mask:0xa bank_mask:0xf
    v_add_f32_dpp v90, v90, v90 row_bcast:31 row_mask:0xc bank_mask:0xf
    v_add_f32_dpp v88, v88, v88 row_bcast:31 row_mask:0xc bank_mask:0xf
    v_add_f32_dpp v96, v96, v96 row_bcast:31 row_mask:0xc bank_mask:0xf
    v_add_f32_dpp v94, v94, v94 row_bcast:31 row_mask:0xc bank_mask:0xf
    v_mul_f32 v88, 0x3b000000, v88
    v_mul_f32 v90, 0x3b000000, v90
    v_fma_f32 v90, -v88, v88, v90
    v_max_f32 v90, 0, v90
    v_add_f32 v90, 0x3727c5ac, v90
    v_mul_f32 v94, 0x3b000000, v94
    v_rsq_f32 v90, v90
    v_mul_f32 v96, 0x3b000000, v96
    v_mul_f32 v90, 0x3fb8aa3b, v90
    v_mul_f32_e64 v88, -v88, v90
    v_readlane_b32 s36, v90, 63
    v_readlane_b32 s38, v88, 63
    v_fma_f32 v96, -v94, v94, v96
    v_max_f32 v96, 0, v96
    v_mov_b32 v92, s38
    v_add_f32 v96, 0x3727c5ac, v96
    v_pk_fma_f32 v[56:57], v[240:241], s[36:37], v[92:93] op_sel_hi:[1,0,0]
    v_rsq_f32 v96, v96
    v_pk_fma_f32 v[58:59], v[242:243], s[36:37], v[92:93] op_sel_hi:[1,0,0]
    v_mul_f32 v96, 0x3fb8aa3b, v96
    v_mul_f32_e64 v94, -v94, v96
    v_readlane_b32 s40, v96, 63
    v_readlane_b32 s42, v94, 63
    v_pk_fma_f32 v[60:61], v[244:245], s[36:37], v[92:93] op_sel_hi:[1,0,0]
    v_pk_fma_f32 v[62:63], v[246:247], s[36:37], v[92:93] op_sel_hi:[1,0,0]
    v_mov_b32 v98, s42
    v_cvt_pk_bf16_f32 v64, v56, v57
    v_cvt_pk_bf16_f32 v65, v58, v59
    v_cvt_pk_bf16_f32 v66, v60, v61
    v_cvt_pk_bf16_f32 v67, v62, v63
    ds_write_b128 v100, v[64:67] offset:44800
    v_pk_fma_f32 v[72:73], v[248:249], s[40:41], v[98:99] op_sel_hi:[1,0,0]
    v_pk_fma_f32 v[74:75], v[250:251], s[40:41], v[98:99] op_sel_hi:[1,0,0]
    v_pk_fma_f32 v[76:77], v[252:253], s[40:41], v[98:99] op_sel_hi:[1,0,0]
    v_pk_fma_f32 v[78:79], v[254:255], s[40:41], v[98:99] op_sel_hi:[1,0,0]
    v_cvt_pk_bf16_f32 v80, v72, v73
    v_cvt_pk_bf16_f32 v81, v74, v75
    v_cvt_pk_bf16_f32 v82, v76, v77
    v_cvt_pk_bf16_f32 v83, v78, v79
    ds_write_b128 v100, v[80:83] offset:0
    s_waitcnt lgkmcnt(0)
    s_barrier
    ds_read_b128 v[56:59], v101 offset:44800
    ds_read_b128 v[60:63], v101 offset:0
    s_waitcnt lgkmcnt(1)
    buffer_store_dwordx4 v[56:59], v12, s[76:79], 0 offen
    s_waitcnt lgkmcnt(0)
    buffer_store_dwordx4 v[60:63], v12, s[76:79], s26 offen
    s_waitcnt vmcnt(8)
    v_cmp_ne_u32 vcc, s7, v229
    s_cbranch_vccnz L14
L15:
    ds_read_b128 v[134:137], v2 offset:0
    ds_read_b128 v[138:141], v2 offset:1024
    ds_read_b128 v[142:145], v2 offset:2048
    ds_read_b128 v[146:149], v2 offset:3072
    ds_read_b128 v[150:153], v2 offset:4096
    ds_read_b128 v[154:157], v2 offset:5120
    ds_read_b128 v[158:161], v2 offset:6144
    s_waitcnt vmcnt(1)
    s_cmp_lg_u32 s11, 0
    s_cbranch_scc1 L17
    buffer_store_dword v4, v3, s[76:79], s95 offen offset:0
L18:
    s_waitcnt vmcnt(1)
    s_cmp_lg_u32 s11, 0
    s_cbranch_scc1 L19
    buffer_store_dword v4, v3, s[76:79], s95 offen offset:512
L20:
    s_or_b32 s12, s2, s6
    s_cmp_eq_u32 s12, 0
    s_cselect_b32 s12, 0, 0x40000000
    buffer_store_dword v4, v3, s[76:79], s12 offen sc1
    s_barrier
    s_add_u32 m0, s35, s83
    s_nop 0
    buffer_load_dwordx4 v215, s[64:67], s27 offen lds
    s_add_u32 m0, s54, s83
    s_nop 0
    buffer_load_dwordx4 v216, s[64:67], s27 offen lds
    s_add_u32 m0, s80, s83
    s_nop 0
    buffer_load_dwordx4 v217, s[64:67], s27 offen lds
    s_add_u32 m0, s81, s83
    s_nop 0
    buffer_load_dwordx4 v218, s[64:67], s27 offen lds
    buffer_load_dword v5, v17, s[76:79], s94 offen offset:0 sc1
    s_waitcnt vmcnt(0)
    v_cmp_ne_u32 vcc, s8, v5
    s_cbranch_vccnz L21
L22:
    buffer_load_dwordx4 v[190:193], v6, s[76:79], 0 offen offset:0 sc1
    buffer_load_dwordx4 v[194:197], v6, s[76:79], 0 offen offset:1024 sc1
    buffer_load_dwordx4 v[198:201], v6, s[76:79], 0 offen offset:2048 sc1
    buffer_load_dwordx4 v[202:205], v6, s[76:79], 0 offen offset:3072 sc1
    buffer_load_dwordx4 v[206:209], v6, s[76:79], s84 offen offset:0 sc1
    buffer_load_dwordx4 v[210:213], v6, s[76:79], s84 offen offset:1024 sc1
    buffer_load_dwordx4 v[214:217], v6, s[76:79], s84 offen offset:2048 sc1
    buffer_load_dwordx4 v[218:221], v6, s[76:79], s84 offen offset:3072 sc1
    buffer_load_dwordx4 a[224:227], v6, s[76:79], s85 offen offset:0 sc1
    buffer_load_dwordx4 a[228:231], v6, s[76:79], s85 offen offset:1024 sc1
    s_waitcnt vmcnt(8) lgkmcnt(0)
    v_mfma_f32_16x16x32_bf16 v[22:25], v[134:137], v[190:193], 0
    ds_read_b128 v[162:165], v2 offset:7168
    ds_read_b128 v[166:169], v2 offset:8192
    v_mfma_f32_16x16x32_bf16 v[50:53], v[134:137], v[194:197], 0
    v_add_u32 v222, 57344, v222
    v_mfma_f32_16x16x32_bf16 v[26:29], v[138:141], v[190:193], 0
    ds_read_b128 v[170:173], v2 offset:9216
    ds_read_b128 v[174:177], v2 offset:10240
    v_mfma_f32_16x16x32_bf16 v[54:57], v[138:141], v[194:197], 0
    v_add_u32 v223, 57344, v223
    v_add_u32 v224, 57344, v224
    v_mfma_f32_16x16x32_bf16 v[30:33], v[142:145], v[190:193], 0
    ds_read_b128 v[178:181], v2 offset:11264
    ds_read_b128 v[182:185], v2 offset:12288
    v_mfma_f32_16x16x32_bf16 v[58:61], v[142:145], v[194:197], 0
    v_add_u32 v225, 57344, v225
    ds_read_b64_tr_b16 a[128:129], v222 offset:0
    v_mfma_f32_16x16x32_bf16 v[34:37], v[146:149], v[190:193], 0
    ds_read_b128 v[186:189], v2 offset:13312
    buffer_load_dwordx4 a[232:235], v6, s[76:79], s85 offen offset:2048 sc1
    v_mfma_f32_16x16x32_bf16 v[62:65], v[146:149], v[194:197], 0
    ds_read_b64_tr_b16 a[130:131], v222 offset:448
    ds_read_b64_tr_b16 a[132:133], v222 offset:7168
    v_mfma_f32_16x16x32_bf16 v[38:41], v[150:153], v[190:193], 0
    buffer_load_dwordx4 a[236:239], v6, s[76:79], s85 offen offset:3072 sc1
    ds_read_b64_tr_b16 a[134:135], v222 offset:7616
    v_mfma_f32_16x16x32_bf16 v[66:69], v[150:153], v[194:197], 0
    ds_read_b64_tr_b16 a[136:137], v222 offset:32
    ds_read_b64_tr_b16 a[138:139], v222 offset:480
    v_mfma_f32_16x16x32_bf16 v[42:45], v[154:157], v[190:193], 0
    buffer_load_dwordx4 a[240:243], v6, s[76:79], s86 offen offset:0 sc1
    ds_read_b64_tr_b16 a[140:141], v222 offset:7200
    v_mfma_f32_16x16x32_bf16 v[70:73], v[154:157], v[194:197], 0
    ds_read_b64_tr_b16 a[142:143], v222 offset:7648
    ds_read_b64_tr_b16 a[144:145], v222 offset:64
    v_mfma_f32_16x16x32_bf16 v[46:49], v[158:161], v[190:193], 0
    buffer_load_dwordx4 a[244:247], v6, s[76:79], s86 offen offset:1024 sc1
    ds_read_b64_tr_b16 a[146:147], v222 offset:512
    v_mfma_f32_16x16x32_bf16 v[74:77], v[158:161], v[194:197], 0
    ds_read_b64_tr_b16 a[148:149], v222 offset:7232
    s_waitcnt vmcnt(10) lgkmcnt(10)
    v_mfma_f32_16x16x32_bf16 v[22:25], v[162:165], v[198:201], v[22:25]
    ds_read_b128 v[134:137], v2 offset:14336
    ds_read_b128 v[138:141], v2 offset:15360
    v_mfma_f32_16x16x32_bf16 v[50:53], v[162:165], v[202:205], v[50:53]
    ds_read_b64_tr_b16 a[150:151], v222 offset:7680
    ds_read_b64_tr_b16 a[152:153], v223 offset:96
    v_mfma_f32_16x16x32_bf16 v[26:29], v[166:169], v[198:201], v[26:29]
    ds_read_b128 v[142:145], v2 offset:16384
    ds_read_b128 v[146:149], v2 offset:17408
    v_mfma_f32_16x16x32_bf16 v[54:57], v[166:169], v[202:205], v[54:57]
    ds_read_b64_tr_b16 a[154:155], v223 offset:544
    ds_read_b64_tr_b16 a[156:157], v222 offset:3584
    v_mfma_f32_16x16x32_bf16 v[30:33], v[170:173], v[198:201], v[30:33]
    ds_read_b128 v[150:153], v2 offset:18432
    ds_read_b128 v[154:157], v2 offset:19456
    v_mfma_f32_16x16x32_bf16 v[58:61], v[170:173], v[202:205], v[58:61]
    ds_read_b64_tr_b16 a[158:159], v222 offset:4032
    ds_read_b64_tr_b16 a[160:161], v222 offset:10752
    v_mfma_f32_16x16x32_bf16 v[34:37], v[174:177], v[198:201], v[34:37]
    ds_read_b128 v[158:161], v2 offset:20480
    buffer_load_dwordx4 a[248:251], v6, s[76:79], s86 offen offset:2048 sc1
    v_mfma_f32_16x16x32_bf16 v[62:65], v[174:177], v[202:205], v[62:65]
    ds_read_b64_tr_b16 a[162:163], v222 offset:11200
    ds_read_b64_tr_b16 a[164:165], v222 offset:3616
    v_mfma_f32_16x16x32_bf16 v[38:41], v[178:181], v[198:201], v[38:41]
    buffer_load_dwordx4 a[252:255], v6, s[76:79], s86 offen offset:3072 sc1
    ds_read_b64_tr_b16 a[166:167], v222 offset:4064
    v_mfma_f32_16x16x32_bf16 v[66:69], v[178:181], v[202:205], v[66:69]
    ds_read_b64_tr_b16 a[168:169], v222 offset:10784
    ds_read_b64_tr_b16 a[170:171], v222 offset:11232
    v_mfma_f32_16x16x32_bf16 v[42:45], v[182:185], v[198:201], v[42:45]
    buffer_load_dwordx4 v[190:193], v6, s[76:79], s87 offen offset:0 sc1
    ds_read_b64_tr_b16 a[172:173], v222 offset:3648
    v_mfma_f32_16x16x32_bf16 v[70:73], v[182:185], v[202:205], v[70:73]
    ds_read_b64_tr_b16 a[174:175], v222 offset:4096
    ds_read_b64_tr_b16 a[176:177], v222 offset:10816
    v_mfma_f32_16x16x32_bf16 v[46:49], v[186:189], v[198:201], v[46:49]
    buffer_load_dwordx4 v[194:197], v6, s[76:79], s87 offen offset:1024 sc1
    ds_read_b64_tr_b16 a[178:179], v222 offset:11264
    v_mfma_f32_16x16x32_bf16 v[74:77], v[186:189], v[202:205], v[74:77]
    ds_read_b64_tr_b16 a[180:181], v223 offset:3680
    s_waitcnt vmcnt(12) lgkmcnt(10)
    v_mfma_f32_16x16x32_bf16 v[22:25], v[134:137], v[206:209], v[22:25]
    ds_read_b128 v[162:165], v2 offset:21504
    ds_read_b128 v[166:169], v2 offset:22528
    v_mfma_f32_16x16x32_bf16 v[50:53], v[134:137], v[210:213], v[50:53]
    buffer_load_dword v5, v17, s[76:79], s94 offen offset:512 sc1
    ds_read_b64_tr_b16 a[182:183], v223 offset:4128
    v_mfma_f32_16x16x32_bf16 v[26:29], v[138:141], v[206:209], v[26:29]
    ds_read_b128 v[170:173], v2 offset:23552
    ds_read_b128 v[174:177], v2 offset:24576
    v_mfma_f32_16x16x32_bf16 v[54:57], v[138:141], v[210:213], v[54:57]
    buffer_load_dwordx4 a[0:3], v230, s[76:79], 0 offen offset:0 sc1
    buffer_load_dwordx4 a[4:7], v230, s[76:79], 0 offen offset:1024 sc1
    v_mfma_f32_16x16x32_bf16 v[30:33], v[142:145], v[206:209], v[30:33]
    ds_read_b128 v[178:181], v2 offset:25600
    ds_read_b128 v[182:185], v2 offset:26624
    v_mfma_f32_16x16x32_bf16 v[58:61], v[142:145], v[210:213], v[58:61]
    s_waitcnt lgkmcnt(4)
    buffer_load_dwordx4 a[8:11], v230, s[76:79], 0 offen offset:2048 sc1
    v_mfma_f32_16x16x32_bf16 v[34:37], v[146:149], v[206:209], v[34:37]
    ds_read_b128 v[186:189], v2 offset:27648
    buffer_load_dwordx4 v[198:201], v6, s[76:79], s87 offen offset:2048 sc1
    v_mfma_f32_16x16x32_bf16 v[62:65], v[146:149], v[210:213], v[62:65]
    ds_write_b128 v224, a[128:131] offset:0
    v_mfma_f32_16x16x32_bf16 v[38:41], v[150:153], v[206:209], v[38:41]
    buffer_load_dwordx4 v[202:205], v6, s[76:79], s87 offen offset:3072 sc1
    buffer_load_dwordx4 a[12:15], v230, s[76:79], 0 offen offset:3072 sc1
    v_mfma_f32_16x16x32_bf16 v[66:69], v[150:153], v[210:213], v[66:69]
    v_mfma_f32_16x16x32_bf16 v[42:45], v[154:157], v[206:209], v[42:45]
    ds_write_b128 v224, a[132:135] offset:1024
    v_mfma_f32_16x16x32_bf16 v[70:73], v[154:157], v[210:213], v[70:73]
    v_mfma_f32_16x16x32_bf16 v[46:49], v[158:161], v[206:209], v[46:49]
    v_mfma_f32_16x16x32_bf16 v[74:77], v[158:161], v[210:213], v[74:77]
    s_waitcnt vmcnt(17) lgkmcnt(2)
    v_mfma_f32_16x16x32_bf16 v[22:25], v[162:165], v[214:217], v[22:25]
    ds_read_b128 v[134:137], v2 offset:28672
    ds_read_b128 v[138:141], v2 offset:29696
    v_mfma_f32_16x16x32_bf16 v[50:53], v[162:165], v[218:221], v[50:53]
    ds_write_b128 v224, a[136:139] offset:2048
    v_mfma_f32_16x16x32_bf16 v[26:29], v[166:169], v[214:217], v[26:29]
    ds_read_b128 v[142:145], v2 offset:30720
    ds_read_b128 v[146:149], v2 offset:31744
    v_mfma_f32_16x16x32_bf16 v[54:57], v[166:169], v[218:221], v[54:57]
    buffer_load_dwordx4 a[16:19], v230, s[76:79], s84 offen offset:0 sc1
    v_mfma_f32_16x16x32_bf16 v[30:33], v[170:173], v[214:217], v[30:33]
    ds_read_b128 v[150:153], v2 offset:32768
    ds_read_b128 v[154:157], v2 offset:33792
    v_mfma_f32_16x16x32_bf16 v[58:61], v[170:173], v[218:221], v[58:61]
    ds_write_b128 v224, a[140:143] offset:3072
    v_mfma_f32_16x16x32_bf16 v[34:37], v[174:177], v[214:217], v[34:37]
    ds_read_b128 v[158:161], v2 offset:34816
    buffer_load_dwordx4 v[206:209], v6, s[76:79], s88 offen offset:0 sc1
    v_mfma_f32_16x16x32_bf16 v[62:65], v[174:177], v[218:221], v[62:65]
    v_mfma_f32_16x16x32_bf16 v[38:41], v[178:181], v[214:217], v[38:41]
    buffer_load_dwordx4 v[210:213], v6, s[76:79], s88 offen offset:1024 sc1
    buffer_load_dwordx4 a[20:23], v230, s[76:79], s84 offen offset:1024 sc1
    v_mfma_f32_16x16x32_bf16 v[66:69], v[178:181], v[218:221], v[66:69]
    ds_write_b128 v224, a[144:147] offset:4096
    v_mfma_f32_16x16x32_bf16 v[42:45], v[182:185], v[214:217], v[42:45]
    v_mfma_f32_16x16x32_bf16 v[70:73], v[182:185], v[218:221], v[70:73]
    v_mfma_f32_16x16x32_bf16 v[46:49], v[186:189], v[214:217], v[46:49]
    ds_write_b128 v224, a[148:151] offset:5120
    v_mfma_f32_16x16x32_bf16 v[74:77], v[186:189], v[218:221], v[74:77]
    s_waitcnt vmcnt(19) lgkmcnt(2)
    v_mfma_f32_16x16x32_bf16 v[22:25], v[134:137], a[224:227], v[22:25]
    ds_read_b128 v[162:165], v2 offset:35840
    ds_read_b128 v[166:169], v2 offset:36864
    v_mfma_f32_16x16x32_bf16 v[50:53], v[134:137], a[228:231], v[50:53]
    buffer_load_dwordx4 a[24:27], v230, s[76:79], s84 offen offset:2048 sc1
    v_mfma_f32_16x16x32_bf16 v[26:29], v[138:141], a[224:227], v[26:29]
    ds_read_b128 v[170:173], v2 offset:37888
    ds_read_b128 v[174:177], v2 offset:38912
    v_mfma_f32_16x16x32_bf16 v[54:57], v[138:141], a[228:231], v[54:57]
    ds_write_b128 v225, a[152:155] offset:6144
    v_mfma_f32_16x16x32_bf16 v[30:33], v[142:145], a[224:227], v[30:33]
    ds_read_b128 v[178:181], v2 offset:39936
    ds_read_b128 v[182:185], v2 offset:40960
    v_mfma_f32_16x16x32_bf16 v[58:61], v[142:145], a[228:231], v[58:61]
    v_mfma_f32_16x16x32_bf16 v[34:37], v[146:149], a[224:227], v[34:37]
    ds_read_b128 v[186:189], v2 offset:41984
    buffer_load_dwordx4 v[214:217], v6, s[76:79], s88 offen offset:2048 sc1
    v_mfma_f32_16x16x32_bf16 v[62:65], v[146:149], a[228:231], v[62:65]
    ds_write_b128 v224, a[156:159] offset:7168
    v_mfma_f32_16x16x32_bf16 v[38:41], v[150:153], a[224:227], v[38:41]
    buffer_load_dwordx4 v[218:221], v6, s[76:79], s88 offen offset:3072 sc1
    buffer_load_dwordx4 a[28:31], v230, s[76:79], s84 offen offset:3072 sc1
    v_mfma_f32_16x16x32_bf16 v[66:69], v[150:153], a[228:231], v[66:69]
    v_mfma_f32_16x16x32_bf16 v[42:45], v[154:157], a[224:227], v[42:45]
    ds_write_b128 v224, a[160:163] offset:8192
    v_mfma_f32_16x16x32_bf16 v[70:73], v[154:157], a[228:231], v[70:73]
    v_mfma_f32_16x16x32_bf16 v[46:49], v[158:161], a[224:227], v[46:49]
    v_mfma_f32_16x16x32_bf16 v[74:77], v[158:161], a[228:231], v[74:77]
    s_waitcnt vmcnt(21) lgkmcnt(2)
    v_mfma_f32_16x16x32_bf16 v[22:25], v[162:165], a[232:235], v[22:25]
    ds_read_b128 v[134:137], v2 offset:43008
    ds_read_b128 v[138:141], v2 offset:44032
    v_mfma_f32_16x16x32_bf16 v[50:53], v[162:165], a[236:239], v[50:53]
    ds_write_b128 v224, a[164:167] offset:9216
    v_mfma_f32_16x16x32_bf16 v[26:29], v[166:169], a[232:235], v[26:29]
    ds_read_b128 v[142:145], v2 offset:45056
    ds_read_b128 v[146:149], v2 offset:46080
    v_mfma_f32_16x16x32_bf16 v[54:57], v[166:169], a[236:239], v[54:57]
    buffer_load_dwordx4 a[32:35], v230, s[76:79], s85 offen offset:0 sc1
    v_mfma_f32_16x16x32_bf16 v[30:33], v[170:173], a[232:235], v[30:33]
    ds_read_b128 v[150:153], v2 offset:47104
    ds_read_b128 v[154:157], v2 offset:48128
    v_mfma_f32_16x16x32_bf16 v[58:61], v[170:173], a[236:239], v[58:61]
    ds_write_b128 v224, a[168:171] offset:10240
    v_mfma_f32_16x16x32_bf16 v[34:37], v[174:177], a[232:235], v[34:37]
    ds_read_b128 v[158:161], v2 offset:49152
    buffer_load_dwordx4 a[224:227], v6, s[76:79], s89 offen offset:0 sc1
    v_mfma_f32_16x16x32_bf16 v[62:65], v[174:177], a[236:239], v[62:65]
    v_mfma_f32_16x16x32_bf16 v[38:41], v[178:181], a[232:235], v[38:41]
    buffer_load_dwordx4 a[228:231], v6, s[76:79], s89 offen offset:1024 sc1
    v_mfma_f32_16x16x32_bf16 v[66:69], v[178:181], a[236:239], v[66:69]
    ds_write_b128 v224, a[172:175] offset:11264
    v_mfma_f32_16x16x32_bf16 v[42:45], v[182:185], a[232:235], v[42:45]
    buffer_load_dwordx4 a[36:39], v230, s[76:79], s85 offen offset:1024 sc1
    v_mfma_f32_16x16x32_bf16 v[70:73], v[182:185], a[236:239], v[70:73]
    v_mfma_f32_16x16x32_bf16 v[46:49], v[186:189], a[232:235], v[46:49]
    ds_write_b128 v224, a[176:179] offset:12288
    v_mfma_f32_16x16x32_bf16 v[74:77], v[186:189], a[236:239], v[74:77]
    s_waitcnt vmcnt(23) lgkmcnt(2)
    v_mfma_f32_16x16x32_bf16 v[22:25], v[134:137], a[240:243], v[22:25]
    ds_read_b128 v[162:165], v2 offset:50176
    ds_read_b128 v[166:169], v2 offset:51200
    v_mfma_f32_16x16x32_bf16 v[50:53], v[134:137], a[244:247], v[50:53]
    v_mfma_f32_16x16x32_bf16 v[26:29], v[138:141], a[240:243], v[26:29]
    ds_read_b128 v[170:173], v2 offset:52224
    ds_read_b128 v[174:177], v2 offset:53248
    v_mfma_f32_16x16x32_bf16 v[54:57], v[138:141], a[244:247], v[54:57]
    ds_write_b128 v225, a[180:183] offset:13312
    v_mfma_f32_16x16x32_bf16 v[30:33], v[142:145], a[240:243], v[30:33]
    ds_read_b128 v[178:181], v2 offset:54272
    ds_read_b128 v[182:185], v2 offset:55296
    v_mfma_f32_16x16x32_bf16 v[58:61], v[142:145], a[244:247], v[58:61]
    buffer_load_dwordx4 a[40:43], v230, s[76:79], s85 offen offset:2048 sc1
    v_mfma_f32_16x16x32_bf16 v[34:37], v[146:149], a[240:243], v[34:37]
    ds_read_b128 v[186:189], v2 offset:56320
    buffer_load_dwordx4 a[232:235], v6, s[76:79], s89 offen offset:2048 sc1
    v_mfma_f32_16x16x32_bf16 v[62:65], v[146:149], a[244:247], v[62:65]
    v_mfma_f32_16x16x32_bf16 v[38:41], v[150:153], a[240:243], v[38:41]
    buffer_load_dwordx4 a[236:239], v6, s[76:79], s89 offen offset:3072 sc1
    v_mfma_f32_16x16x32_bf16 v[66:69], v[150:153], a[244:247], v[66:69]
    buffer_load_dwordx4 a[44:47], v230, s[76:79], s85 offen offset:3072 sc1
    v_mfma_f32_16x16x32_bf16 v[42:45], v[154:157], a[240:243], v[42:45]
    v_mfma_f32_16x16x32_bf16 v[70:73], v[154:157], a[244:247], v[70:73]
    v_mfma_f32_16x16x32_bf16 v[46:49], v[158:161], a[240:243], v[46:49]
    v_mfma_f32_16x16x32_bf16 v[74:77], v[158:161], a[244:247], v[74:77]
    s_waitcnt lgkmcnt(0)
    s_barrier
    s_waitcnt vmcnt(25)
    v_mfma_f32_16x16x32_bf16 v[22:25], v[162:165], a[248:251], v[22:25]
    ds_read_b128 v[134:137], v19 offset:0
    ds_read_b128 v[138:141], v19 offset:1024
    v_mfma_f32_16x16x32_bf16 v[50:53], v[162:165], a[252:255], v[50:53]
    s_waitcnt vmcnt(22)
    v_cmp_ne_u32 vcc, s8, v5
    v_mfma_f32_16x16x32_bf16 v[26:29], v[166:169], a[248:251], v[26:29]
    ds_read_b128 v[142:145], v19 offset:2048
    ds_read_b128 v[146:149], v19 offset:3072
    v_mfma_f32_16x16x32_bf16 v[54:57], v[166:169], a[252:255], v[54:57]
    s_cbranch_vccnz L24
L25:
    buffer_load_dwordx4 a[48:51], v230, s[76:79], s86 offen offset:0 sc1
    v_mfma_f32_16x16x32_bf16 v[30:33], v[170:173], a[248:251], v[30:33]
    ds_read_b128 v[150:153], v19 offset:4096
    ds_read_b128 v[154:157], v19 offset:5120
    v_mfma_f32_16x16x32_bf16 v[58:61], v[170:173], a[252:255], v[58:61]
    v_mfma_f32_16x16x32_bf16 v[34:37], v[174:177], a[248:251], v[34:37]
    ds_read_b128 v[158:161], v19 offset:6144
    buffer_load_dwordx4 a[240:243], v6, s[76:79], s90 offen offset:0 sc1
    v_mfma_f32_16x16x32_bf16 v[62:65], v[174:177], a[252:255], v[62:65]
    v_mfma_f32_16x16x32_bf16 v[38:41], v[178:181], a[248:251], v[38:41]
    buffer_load_dwordx4 a[244:247], v6, s[76:79], s90 offen offset:1024 sc1
    v_mfma_f32_16x16x32_bf16 v[66:69], v[178:181], a[252:255], v[66:69]
    v_mfma_f32_16x16x32_bf16 v[42:45], v[182:185], a[248:251], v[42:45]
    buffer_load_dwordx4 a[52:55], v230, s[76:79], s86 offen offset:1024 sc1
    v_mfma_f32_16x16x32_bf16 v[70:73], v[182:185], a[252:255], v[70:73]
    v_mfma_f32_16x16x32_bf16 v[46:49], v[186:189], a[248:251], v[46:49]
    v_mfma_f32_16x16x32_bf16 v[74:77], v[186:189], a[252:255], v[74:77]
    s_waitcnt lgkmcnt(0)
    v_mfma_f32_16x16x32_bf16 v[22:25], v[134:137], v[190:193], v[22:25]
    ds_read_b128 v[162:165], v19 offset:7168
    ds_read_b128 v[166:169], v19 offset:8192
    v_mfma_f32_16x16x32_bf16 v[50:53], v[134:137], v[194:197], v[50:53]
    v_mfma_f32_16x16x32_bf16 v[26:29], v[138:141], v[190:193], v[26:29]
    ds_read_b128 v[170:173], v19 offset:9216
    ds_read_b128 v[174:177], v19 offset:10240
    v_mfma_f32_16x16x32_bf16 v[54:57], v[138:141], v[194:197], v[54:57]
    buffer_load_dwordx4 a[56:59], v230, s[76:79], s86 offen offset:2048 sc1
    v_mfma_f32_16x16x32_bf16 v[30:33], v[142:145], v[190:193], v[30:33]
    ds_read_b128 v[178:181], v19 offset:11264
    ds_read_b128 v[182:185], v19 offset:12288
    v_mfma_f32_16x16x32_bf16 v[58:61], v[142:145], v[194:197], v[58:61]
    v_mfma_f32_16x16x32_bf16 v[34:37], v[146:149], v[190:193], v[34:37]
    ds_read_b128 v[186:189], v19 offset:13312
    buffer_load_dwordx4 a[248:251], v6, s[76:79], s90 offen offset:2048 sc1
    v_mfma_f32_16x16x32_bf16 v[62:65], v[146:149], v[194:197], v[62:65]
    v_mfma_f32_16x16x32_bf16 v[38:41], v[150:153], v[190:193], v[38:41]
    buffer_load_dwordx4 a[252:255], v6, s[76:79], s90 offen offset:3072 sc1
    v_mfma_f32_16x16x32_bf16 v[66:69], v[150:153], v[194:197], v[66:69]
    v_mfma_f32_16x16x32_bf16 v[42:45], v[154:157], v[190:193], v[42:45]
    buffer_load_dwordx4 a[60:63], v230, s[76:79], s86 offen offset:3072 sc1
    v_mfma_f32_16x16x32_bf16 v[70:73], v[154:157], v[194:197], v[70:73]
    v_mfma_f32_16x16x32_bf16 v[46:49], v[158:161], v[190:193], v[46:49]
    v_mfma_f32_16x16x32_bf16 v[74:77], v[158:161], v[194:197], v[74:77]
    s_waitcnt vmcnt(25) lgkmcnt(0)
    v_mfma_f32_16x16x32_bf16 v[22:25], v[162:165], v[198:201], v[22:25]
    ds_read_b128 v[134:137], v19 offset:14336
    ds_read_b128 v[138:141], v19 offset:15360
    v_mfma_f32_16x16x32_bf16 v[50:53], v[162:165], v[202:205], v[50:53]
    v_mfma_f32_16x16x32_bf16 v[26:29], v[166:169], v[198:201], v[26:29]
    ds_read_b128 v[142:145], v19 offset:16384
    ds_read_b128 v[146:149], v19 offset:17408
    v_mfma_f32_16x16x32_bf16 v[54:57], v[166:169], v[202:205], v[54:57]
    v_mfma_f32_16x16x32_bf16 v[30:33], v[170:173], v[198:201], v[30:33]
    ds_read_b128 v[150:153], v19 offset:18432
    ds_read_b128 v[154:157], v19 offset:19456
    v_mfma_f32_16x16x32_bf16 v[58:61], v[170:173], v[202:205], v[58:61]
    buffer_load_dwordx4 a[64:67], v230, s[76:79], s87 offen offset:0 sc1
    v_mfma_f32_16x16x32_bf16 v[34:37], v[174:177], v[198:201], v[34:37]
    ds_read_b128 v[158:161], v19 offset:20480
    buffer_load_dwordx4 v[190:193], v7, s[76:79], 0 offen offset:0 sc1
    v_mfma_f32_16x16x32_bf16 v[62:65], v[174:177], v[202:205], v[62:65]
    v_mfma_f32_16x16x32_bf16 v[38:41], v[178:181], v[198:201], v[38:41]
    buffer_load_dwordx4 v[194:197], v7, s[76:79], 0 offen offset:1024 sc1
    v_mfma_f32_16x16x32_bf16 v[66:69], v[178:181], v[202:205], v[66:69]
    v_mfma_f32_16x16x32_bf16 v[42:45], v[182:185], v[198:201], v[42:45]
    v_mfma_f32_16x16x32_bf16 v[70:73], v[182:185], v[202:205], v[70:73]
    buffer_load_dwordx4 a[68:71], v230, s[76:79], s87 offen offset:1024 sc1
    v_mfma_f32_16x16x32_bf16 v[46:49], v[186:189], v[198:201], v[46:49]
    v_mfma_f32_16x16x32_bf16 v[74:77], v[186:189], v[202:205], v[74:77]
    s_waitcnt vmcnt(25) lgkmcnt(0)
    v_mfma_f32_16x16x32_bf16 v[22:25], v[134:137], v[206:209], v[22:25]
    ds_read_b128 v[162:165], v19 offset:21504
    ds_read_b128 v[166:169], v19 offset:22528
    v_mfma_f32_16x16x32_bf16 v[50:53], v[134:137], v[210:213], v[50:53]
    v_mfma_f32_16x16x32_bf16 v[26:29], v[138:141], v[206:209], v[26:29]
    ds_read_b128 v[170:173], v19 offset:23552
    ds_read_b128 v[174:177], v19 offset:24576
    v_mfma_f32_16x16x32_bf16 v[54:57], v[138:141], v[210:213], v[54:57]
    v_mfma_f32_16x16x32_bf16 v[30:33], v[142:145], v[206:209], v[30:33]
    ds_read_b128 v[178:181], v19 offset:25600
    ds_read_b128 v[182:185], v19 offset:26624
    v_mfma_f32_16x16x32_bf16 v[58:61], v[142:145], v[210:213], v[58:61]
    buffer_load_dwordx4 a[72:75], v230, s[76:79], s87 offen offset:2048 sc1
    v_mfma_f32_16x16x32_bf16 v[34:37], v[146:149], v[206:209], v[34:37]
    ds_read_b128 v[186:189], v19 offset:27648
    buffer_load_dwordx4 v[198:201], v7, s[76:79], 0 offen offset:2048 sc1
    v_mfma_f32_16x16x32_bf16 v[62:65], v[146:149], v[210:213], v[62:65]
    v_mfma_f32_16x16x32_bf16 v[38:41], v[150:153], v[206:209], v[38:41]
    buffer_load_dwordx4 v[202:205], v7, s[76:79], 0 offen offset:3072 sc1
    v_mfma_f32_16x16x32_bf16 v[66:69], v[150:153], v[210:213], v[66:69]
    v_mfma_f32_16x16x32_bf16 v[42:45], v[154:157], v[206:209], v[42:45]
    v_mfma_f32_16x16x32_bf16 v[70:73], v[154:157], v[210:213], v[70:73]
    buffer_load_dwordx4 a[76:79], v230, s[76:79], s87 offen offset:3072 sc1
    v_mfma_f32_16x16x32_bf16 v[46:49], v[158:161], v[206:209], v[46:49]
    v_mfma_f32_16x16x32_bf16 v[74:77], v[158:161], v[210:213], v[74:77]
    s_waitcnt vmcnt(25) lgkmcnt(0)
    v_mfma_f32_16x16x32_bf16 v[22:25], v[162:165], v[214:217], v[22:25]
    ds_read_b128 v[134:137], v19 offset:28672
    ds_read_b128 v[138:141], v19 offset:29696
    v_mfma_f32_16x16x32_bf16 v[50:53], v[162:165], v[218:221], v[50:53]
    v_mfma_f32_16x16x32_bf16 v[26:29], v[166:169], v[214:217], v[26:29]
    ds_read_b128 v[142:145], v19 offset:30720
    ds_read_b128 v[146:149], v19 offset:31744
    v_mfma_f32_16x16x32_bf16 v[54:57], v[166:169], v[218:221], v[54:57]
    v_mfma_f32_16x16x32_bf16 v[30:33], v[170:173], v[214:217], v[30:33]
    ds_read_b128 v[150:153], v19 offset:32768
    ds_read_b128 v[154:157], v19 offset:33792
    v_mfma_f32_16x16x32_bf16 v[58:61], v[170:173], v[218:221], v[58:61]
    buffer_load_dwordx4 a[80:83], v230, s[76:79], s88 offen offset:0 sc1
    v_mfma_f32_16x16x32_bf16 v[34:37], v[174:177], v[214:217], v[34:37]
    ds_read_b128 v[158:161], v19 offset:34816
    buffer_load_dwordx4 v[206:209], v7, s[76:79], s84 offen offset:0 sc1
    v_mfma_f32_16x16x32_bf16 v[62:65], v[174:177], v[218:221], v[62:65]
    v_mfma_f32_16x16x32_bf16 v[38:41], v[178:181], v[214:217], v[38:41]
    buffer_load_dwordx4 v[210:213], v7, s[76:79], s84 offen offset:1024 sc1
    v_mfma_f32_16x16x32_bf16 v[66:69], v[178:181], v[218:221], v[66:69]
    v_mfma_f32_16x16x32_bf16 v[42:45], v[182:185], v[214:217], v[42:45]
    v_mfma_f32_16x16x32_bf16 v[70:73], v[182:185], v[218:221], v[70:73]
    v_mfma_f32_16x16x32_bf16 v[46:49], v[186:189], v[214:217], v[46:49]
    buffer_load_dwordx4 a[84:87], v230, s[76:79], s88 offen offset:1024 sc1
    v_mfma_f32_16x16x32_bf16 v[74:77], v[186:189], v[218:221], v[74:77]
    s_waitcnt vmcnt(25) lgkmcnt(0)
    v_mfma_f32_16x16x32_bf16 v[22:25], v[134:137], a[224:227], v[22:25]
    ds_read_b128 v[162:165], v19 offset:35840
    ds_read_b128 v[166:169], v19 offset:36864
    v_mfma_f32_16x16x32_bf16 v[50:53], v[134:137], a[228:231], v[50:53]
    v_mfma_f32_16x16x32_bf16 v[26:29], v[138:141], a[224:227], v[26:29]
    ds_read_b128 v[170:173], v19 offset:37888
    ds_read_b128 v[174:177], v19 offset:38912
    v_mfma_f32_16x16x32_bf16 v[54:57], v[138:141], a[228:231], v[54:57]
    v_mfma_f32_16x16x32_bf16 v[30:33], v[142:145], a[224:227], v[30:33]
    ds_read_b128 v[178:181], v19 offset:39936
    ds_read_b128 v[182:185], v19 offset:40960
    v_mfma_f32_16x16x32_bf16 v[58:61], v[142:145], a[228:231], v[58:61]
    buffer_load_dwordx4 a[88:91], v230, s[76:79], s88 offen offset:2048 sc1
    v_mfma_f32_16x16x32_bf16 v[34:37], v[146:149], a[224:227], v[34:37]
    ds_read_b128 v[186:189], v19 offset:41984
    buffer_load_dwordx4 v[214:217], v7, s[76:79], s84 offen offset:2048 sc1
    v_mfma_f32_16x16x32_bf16 v[62:65], v[146:149], a[228:231], v[62:65]
    v_mfma_f32_16x16x32_bf16 v[38:41], v[150:153], a[224:227], v[38:41]
    buffer_load_dwordx4 v[218:221], v7, s[76:79], s84 offen offset:3072 sc1
    v_mfma_f32_16x16x32_bf16 v[66:69], v[150:153], a[228:231], v[66:69]
    v_mfma_f32_16x16x32_bf16 v[42:45], v[154:157], a[224:227], v[42:45]
    v_mfma_f32_16x16x32_bf16 v[70:73], v[154:157], a[228:231], v[70:73]
    v_mfma_f32_16x16x32_bf16 v[46:49], v[158:161], a[224:227], v[46:49]
    buffer_load_dwordx4 a[92:95], v230, s[76:79], s88 offen offset:3072 sc1
    v_mfma_f32_16x16x32_bf16 v[74:77], v[158:161], a[228:231], v[74:77]
    s_waitcnt vmcnt(25) lgkmcnt(0)
    v_mfma_f32_16x16x32_bf16 v[22:25], v[162:165], a[232:235], v[22:25]
    ds_read_b128 v[134:137], v19 offset:43008
    ds_read_b128 v[138:141], v19 offset:44032
    v_mfma_f32_16x16x32_bf16 v[50:53], v[162:165], a[236:239], v[50:53]
    v_mfma_f32_16x16x32_bf16 v[26:29], v[166:169], a[232:235], v[26:29]
    ds_read_b128 v[142:145], v19 offset:45056
    ds_read_b128 v[146:149], v19 offset:46080
    v_mfma_f32_16x16x32_bf16 v[54:57], v[166:169], a[236:239], v[54:57]
    v_mfma_f32_16x16x32_bf16 v[30:33], v[170:173], a[232:235], v[30:33]
    ds_read_b128 v[150:153], v19 offset:47104
    ds_read_b128 v[154:157], v19 offset:48128
    v_mfma_f32_16x16x32_bf16 v[58:61], v[170:173], a[236:239], v[58:61]
    v_mfma_f32_16x16x32_bf16 v[34:37], v[174:177], a[232:235], v[34:37]
    ds_read_b128 v[158:161], v19 offset:49152
    buffer_load_dwordx4 a[224:227], v7, s[76:79], s85 offen offset:0 sc1
    v_mfma_f32_16x16x32_bf16 v[62:65], v[174:177], a[236:239], v[62:65]
    buffer_load_dwordx4 a[96:99], v230, s[76:79], s89 offen offset:0 sc1
    v_mfma_f32_16x16x32_bf16 v[38:41], v[178:181], a[232:235], v[38:41]
    buffer_load_dwordx4 a[228:231], v7, s[76:79], s85 offen offset:1024 sc1
    v_mfma_f32_16x16x32_bf16 v[66:69], v[178:181], a[236:239], v[66:69]
    v_mfma_f32_16x16x32_bf16 v[42:45], v[182:185], a[232:235], v[42:45]
    v_mfma_f32_16x16x32_bf16 v[70:73], v[182:185], a[236:239], v[70:73]
    v_mfma_f32_16x16x32_bf16 v[46:49], v[186:189], a[232:235], v[46:49]
    v_mfma_f32_16x16x32_bf16 v[74:77], v[186:189], a[236:239], v[74:77]
    buffer_load_dwordx4 a[100:103], v230, s[76:79], s89 offen offset:1024 sc1
    s_waitcnt vmcnt(25) lgkmcnt(0)
    v_mfma_f32_16x16x32_bf16 v[22:25], v[134:137], a[240:243], v[22:25]
    ds_read_b128 v[162:165], v19 offset:50176
    ds_read_b128 v[166:169], v19 offset:51200
    v_mfma_f32_16x16x32_bf16 v[50:53], v[134:137], a[244:247], v[50:53]
    v_mfma_f32_16x16x32_bf16 v[26:29], v[138:141], a[240:243], v[26:29]
    ds_read_b128 v[170:173], v19 offset:52224
    ds_read_b128 v[174:177], v19 offset:53248
    v_mfma_f32_16x16x32_bf16 v[54:57], v[138:141], a[244:247], v[54:57]
    v_mfma_f32_16x16x32_bf16 v[30:33], v[142:145], a[240:243], v[30:33]
    ds_read_b128 v[178:181], v19 offset:54272
    ds_read_b128 v[182:185], v19 offset:55296
    v_mfma_f32_16x16x32_bf16 v[58:61], v[142:145], a[244:247], v[58:61]
    v_mfma_f32_16x16x32_bf16 v[34:37], v[146:149], a[240:243], v[34:37]
    ds_read_b128 v[186:189], v19 offset:56320
    buffer_load_dwordx4 a[232:235], v7, s[76:79], s85 offen offset:2048 sc1
    v_mfma_f32_16x16x32_bf16 v[62:65], v[146:149], a[244:247], v[62:65]
    buffer_load_dwordx4 a[104:107], v230, s[76:79], s89 offen offset:2048 sc1
    v_mfma_f32_16x16x32_bf16 v[38:41], v[150:153], a[240:243], v[38:41]
    buffer_load_dwordx4 a[236:239], v7, s[76:79], s85 offen offset:3072 sc1
    v_mfma_f32_16x16x32_bf16 v[66:69], v[150:153], a[244:247], v[66:69]
    v_mfma_f32_16x16x32_bf16 v[42:45], v[154:157], a[240:243], v[42:45]
    v_mfma_f32_16x16x32_bf16 v[70:73], v[154:157], a[244:247], v[70:73]
    v_mfma_f32_16x16x32_bf16 v[46:49], v[158:161], a[240:243], v[46:49]
    v_mfma_f32_16x16x32_bf16 v[74:77], v[158:161], a[244:247], v[74:77]
    buffer_load_dwordx4 a[108:111], v230, s[76:79], s89 offen offset:3072 sc1
    s_waitcnt vmcnt(25) lgkmcnt(0)
    v_mfma_f32_16x16x32_bf16 v[22:25], v[162:165], a[248:251], v[22:25]
    ds_read_b128 v[134:137], v2 offset:0
    ds_read_b128 v[138:141], v2 offset:1024
    v_mfma_f32_16x16x32_bf16 v[50:53], v[162:165], a[252:255], v[50:53]
    v_mfma_f32_16x16x32_bf16 v[26:29], v[166:169], a[248:251], v[26:29]
    ds_read_b128 v[142:145], v2 offset:2048
    ds_read_b128 v[146:149], v2 offset:3072
    v_mfma_f32_16x16x32_bf16 v[54:57], v[166:169], a[252:255], v[54:57]
    v_mfma_f32_16x16x32_bf16 v[30:33], v[170:173], a[248:251], v[30:33]
    ds_read_b128 v[150:153], v2 offset:4096
    ds_read_b128 v[154:157], v2 offset:5120
    v_mfma_f32_16x16x32_bf16 v[58:61], v[170:173], a[252:255], v[58:61]
    v_mfma_f32_16x16x32_bf16 v[34:37], v[174:177], a[248:251], v[34:37]
    ds_read_b128 v[158:161], v2 offset:6144
    buffer_load_dwordx4 a[240:243], v7, s[76:79], s86 offen offset:0 sc1
    v_mfma_f32_16x16x32_bf16 v[62:65], v[174:177], a[252:255], v[62:65]
    buffer_load_dwordx4 a[112:115], v230, s[76:79], s90 offen offset:0 sc1
    v_mfma_f32_16x16x32_bf16 v[38:41], v[178:181], a[248:251], v[38:41]
    buffer_load_dwordx4 a[244:247], v7, s[76:79], s86 offen offset:1024 sc1
    v_mfma_f32_16x16x32_bf16 v[66:69], v[178:181], a[252:255], v[66:69]
    v_mfma_f32_16x16x32_bf16 v[42:45], v[182:185], a[248:251], v[42:45]
    v_mfma_f32_16x16x32_bf16 v[70:73], v[182:185], a[252:255], v[70:73]
    v_mfma_f32_16x16x32_bf16 v[46:49], v[186:189], a[248:251], v[46:49]
    v_mfma_f32_16x16x32_bf16 v[74:77], v[186:189], a[252:255], v[74:77]
    v_exp_f32_e64 v222, -v22
    v_pk_mul_f32 v[26:27], v[22:23], v[26:27]
    v_exp_f32_e64 v223, -v23
    v_pk_mul_f32 v[28:29], v[24:25], v[28:29]
    v_exp_f32_e64 v224, -v24
    v_pk_fma_f32 v[222:223], v[222:223], s[24:25], s[24:25]
    v_exp_f32_e64 v225, -v25
    v_rcp_f32 v222, v222
    v_pk_fma_f32 v[224:225], v[224:225], s[24:25], s[24:25]
    v_rcp_f32 v223, v223
    v_pk_mul_f32 v[34:35], v[30:31], v[34:35]
    v_rcp_f32 v224, v224
    v_pk_mul_f32 v[26:27], v[26:27], v[222:223]
    v_rcp_f32 v225, v225
    v_cvt_pk_bf16_f32 v22, v26, v27
    v_pk_mul_f32 v[28:29], v[28:29], v[224:225]
    v_exp_f32_e64 v226, -v30
    v_cvt_pk_bf16_f32 v23, v28, v29
    v_exp_f32_e64 v227, -v31
    v_exp_f32_e64 v228, -v32
    v_pk_mul_f32 v[36:37], v[32:33], v[36:37]
    v_exp_f32_e64 v229, -v33
    v_pk_fma_f32 v[226:227], v[226:227], s[24:25], s[24:25]
    v_pk_fma_f32 v[228:229], v[228:229], s[24:25], s[24:25]
    v_rcp_f32 v226, v226
    v_rcp_f32 v227, v227
    v_pk_mul_f32 v[42:43], v[38:39], v[42:43]
    v_rcp_f32 v228, v228
    v_pk_mul_f32 v[34:35], v[34:35], v[226:227]
    v_rcp_f32 v229, v229
    v_cvt_pk_bf16_f32 v24, v34, v35
    v_pk_mul_f32 v[36:37], v[36:37], v[228:229]
    v_exp_f32_e64 v222, -v38
    v_cvt_pk_bf16_f32 v25, v36, v37
    v_exp_f32_e64 v223, -v39
    buffer_store_dwordx4 v[22:25], v10, s[76:79], 0 offen offset:0 sc1
    v_exp_f32_e64 v224, -v40
    v_exp_f32_e64 v225, -v41
    v_pk_mul_f32 v[44:45], v[40:41], v[44:45]
    v_pk_fma_f32 v[222:223], v[222:223], s[24:25], s[24:25]
    v_rcp_f32 v222, v222
    v_pk_fma_f32 v[224:225], v[224:225], s[24:25], s[24:25]
    v_rcp_f32 v223, v223
    v_rcp_f32 v224, v224
    v_pk_mul_f32 v[42:43], v[42:43], v[222:223]
    v_rcp_f32 v225, v225
    v_cvt_pk_bf16_f32 v30, v42, v43
    v_pk_mul_f32 v[44:45], v[44:45], v[224:225]
    v_exp_f32_e64 v226, -v46
    v_cvt_pk_bf16_f32 v31, v44, v45
    v_exp_f32_e64 v227, -v47
    v_pk_mul_f32 v[48:49], v[46:47], v[48:49]
    v_pk_fma_f32 v[226:227], v[226:227], s[24:25], s[24:25]
    v_mov_b32 v27, v30
    v_rcp_f32 v226, v226
    v_mov_b32 v28, v31
    v_rcp_f32 v227, v227
    s_nop 0
    v_pk_mul_f32 v[48:49], v[48:49], v[226:227]
    v_cvt_pk_bf16_f32 v32, v48, v49
    v_mov_b32 v26, v32
    v_permlane32_swap_b32 v28, v33
    s_nop 0
    v_permlane32_swap_b32 v27, v26
    s_nop 1
    v_permlane16_swap_b32 v26, v33
    buffer_store_dwordx4 v[30:33], v11, s[76:79], 0 offen offset:0 sc1
    s_waitcnt vmcnt(26) lgkmcnt(0)
    v_mfma_f32_16x16x32_bf16 v[78:81], v[134:137], v[190:193], 0
    ds_read_b128 v[162:165], v2 offset:7168
    ds_read_b128 v[166:169], v2 offset:8192
    v_mfma_f32_16x16x32_bf16 v[106:109], v[134:137], v[194:197], 0
    buffer_load_dwordx4 a[116:119], v230, s[76:79], s90 offen offset:1024 sc1
    v_mfma_f32_16x16x32_bf16 v[82:85], v[138:141], v[190:193], 0
    ds_read_b128 v[170:173], v2 offset:9216
    ds_read_b128 v[174:177], v2 offset:10240
    v_mfma_f32_16x16x32_bf16 v[110:113], v[138:141], v[194:197], 0
    v_mfma_f32_16x16x32_bf16 v[86:89], v[142:145], v[190:193], 0
    ds_read_b128 v[178:181], v2 offset:11264
    ds_read_b128 v[182:185], v2 offset:12288
    v_mfma_f32_16x16x32_bf16 v[114:117], v[142:145], v[194:197], 0
    v_exp_f32_e64 v222, -v50
    v_mfma_f32_16x16x32_bf16 v[90:93], v[146:149], v[190:193], 0
    ds_read_b128 v[186:189], v2 offset:13312
    buffer_load_dwordx4 a[248:251], v7, s[76:79], s86 offen offset:2048 sc1
    v_mfma_f32_16x16x32_bf16 v[118:121], v[146:149], v[194:197], 0
    buffer_load_dwordx4 a[120:123], v230, s[76:79], s90 offen offset:2048 sc1
    v_mul_f32 v54, v50, v54
    v_mfma_f32_16x16x32_bf16 v[94:97], v[150:153], v[190:193], 0
    buffer_load_dwordx4 a[252:255], v7, s[76:79], s86 offen offset:3072 sc1
    v_mul_f32 v55, v51, v55
    v_mfma_f32_16x16x32_bf16 v[122:125], v[150:153], v[194:197], 0
    v_exp_f32_e64 v223, -v51
    v_mfma_f32_16x16x32_bf16 v[98:101], v[154:157], v[190:193], 0
    v_exp_f32_e64 v224, -v52
    v_mfma_f32_16x16x32_bf16 v[126:129], v[154:157], v[194:197], 0
    v_exp_f32_e64 v225, -v53
    v_mfma_f32_16x16x32_bf16 v[102:105], v[158:161], v[190:193], 0
    v_mul_f32 v56, v52, v56
    v_mul_f32 v57, v53, v57
    v_mfma_f32_16x16x32_bf16 v[130:133], v[158:161], v[194:197], 0
    v_fma_f32 v222, v222, s24, s24
    s_waitcnt vmcnt(26) lgkmcnt(0)
    v_mfma_f32_16x16x32_bf16 v[78:81], v[162:165], v[198:201], v[78:81]
    ds_read_b128 v[134:137], v2 offset:14336
    ds_read_b128 v[138:141], v2 offset:15360
    v_mfma_f32_16x16x32_bf16 v[106:109], v[162:165], v[202:205], v[106:109]
    buffer_load_dwordx4 a[124:127], v230, s[76:79], s90 offen offset:3072 sc1
    v_fma_f32 v223, v223, s24, s24
    v_mfma_f32_16x16x32_bf16 v[82:85], v[166:169], v[198:201], v[82:85]
    ds_read_b128 v[142:145], v2 offset:16384
    ds_read_b128 v[146:149], v2 offset:17408
    v_mfma_f32_16x16x32_bf16 v[110:113], v[166:169], v[202:205], v[110:113]
    v_rcp_f32 v222, v222
    v_mfma_f32_16x16x32_bf16 v[86:89], v[170:173], v[198:201], v[86:89]
    ds_read_b128 v[150:153], v2 offset:18432
    ds_read_b128 v[154:157], v2 offset:19456
    v_mfma_f32_16x16x32_bf16 v[114:117], v[170:173], v[202:205], v[114:117]
    v_rcp_f32 v223, v223
    v_mfma_f32_16x16x32_bf16 v[90:93], v[174:177], v[198:201], v[90:93]
    ds_read_b128 v[158:161], v2 offset:20480
    buffer_load_dwordx4 v[190:193], v7, s[76:79], s87 offen offset:0 sc1
    v_mfma_f32_16x16x32_bf16 v[118:121], v[174:177], v[202:205], v[118:121]
    v_exp_f32_e64 v226, -v58
    v_mfma_f32_16x16x32_bf16 v[94:97], v[178:181], v[198:201], v[94:97]
    buffer_load_dwordx4 v[194:197], v7, s[76:79], s87 offen offset:1024 sc1
    buffer_load_dwordx4 a[128:131], v231, s[76:79], 0 offen offset:0 sc1
    v_mfma_f32_16x16x32_bf16 v[122:125], v[178:181], v[202:205], v[122:125]
    v_exp_f32_e64 v227, -v59
    v_mfma_f32_16x16x32_bf16 v[98:101], v[182:185], v[198:201], v[98:101]
    v_exp_f32_e64 v228, -v60
    v_mfma_f32_16x16x32_bf16 v[126:129], v[182:185], v[202:205], v[126:129]
    v_exp_f32_e64 v229, -v61
    v_mfma_f32_16x16x32_bf16 v[102:105], v[186:189], v[198:201], v[102:105]
    v_fma_f32 v224, v224, s24, s24
    v_fma_f32 v225, v225, s24, s24
    v_mfma_f32_16x16x32_bf16 v[130:133], v[186:189], v[202:205], v[130:133]
    v_mul_f32 v54, v54, v222
    s_waitcnt vmcnt(26) lgkmcnt(0)
    v_mfma_f32_16x16x32_bf16 v[78:81], v[134:137], v[206:209], v[78:81]
    ds_read_b128 v[162:165], v2 offset:21504
    ds_read_b128 v[166:169], v2 offset:22528
    v_mfma_f32_16x16x32_bf16 v[106:109], v[134:137], v[210:213], v[106:109]
    buffer_load_dwordx4 a[132:135], v231, s[76:79], 0 offen offset:1024 sc1
    v_mul_f32 v55, v55, v223
    v_mfma_f32_16x16x32_bf16 v[82:85], v[138:141], v[206:209], v[82:85]
    ds_read_b128 v[170:173], v2 offset:23552
    ds_read_b128 v[174:177], v2 offset:24576
    v_mfma_f32_16x16x32_bf16 v[110:113], v[138:141], v[210:213], v[110:113]
    v_rcp_f32 v224, v224
    v_mfma_f32_16x16x32_bf16 v[86:89], v[142:145], v[206:209], v[86:89]
    ds_read_b128 v[178:181], v2 offset:25600
    ds_read_b128 v[182:185], v2 offset:26624
    v_mfma_f32_16x16x32_bf16 v[114:117], v[142:145], v[210:213], v[114:117]
    v_rcp_f32 v225, v225
    v_mfma_f32_16x16x32_bf16 v[90:93], v[146:149], v[206:209], v[90:93]
    ds_read_b128 v[186:189], v2 offset:27648
    buffer_load_dwordx4 v[198:201], v7, s[76:79], s87 offen offset:2048 sc1
    v_mfma_f32_16x16x32_bf16 v[118:121], v[146:149], v[210:213], v[118:121]
    v_mul_f32 v56, v56, v224
    v_mul_f32 v57, v57, v225
    v_mfma_f32_16x16x32_bf16 v[94:97], v[150:153], v[206:209], v[94:97]
    buffer_load_dwordx4 v[202:205], v7, s[76:79], s87 offen offset:3072 sc1
    buffer_load_dwordx4 a[136:139], v231, s[76:79], 0 offen offset:2048 sc1
    v_mfma_f32_16x16x32_bf16 v[122:125], v[150:153], v[210:213], v[122:125]
    v_cvt_pk_bf16_f32 v50, v54, v55
    v_cvt_pk_bf16_f32 v51, v56, v57
    v_mfma_f32_16x16x32_bf16 v[98:101], v[154:157], v[206:209], v[98:101]
    v_mul_f32 v62, v58, v62
    v_mul_f32 v63, v59, v63
    v_mfma_f32_16x16x32_bf16 v[126:129], v[154:157], v[210:213], v[126:129]
    v_mul_f32 v64, v60, v64
    v_mul_f32 v65, v61, v65
    v_mfma_f32_16x16x32_bf16 v[102:105], v[158:161], v[206:209], v[102:105]
    v_fma_f32 v226, v226, s24, s24
    v_fma_f32 v227, v227, s24, s24
    v_mfma_f32_16x16x32_bf16 v[130:133], v[158:161], v[210:213], v[130:133]
    v_fma_f32 v228, v228, s24, s24
    s_waitcnt vmcnt(26) lgkmcnt(0)
    v_mfma_f32_16x16x32_bf16 v[78:81], v[162:165], v[214:217], v[78:81]
    ds_read_b128 v[134:137], v2 offset:28672
    ds_read_b128 v[138:141], v2 offset:29696
    v_mfma_f32_16x16x32_bf16 v[106:109], v[162:165], v[218:221], v[106:109]
    buffer_load_dwordx4 a[140:143], v231, s[76:79], 0 offen offset:3072 sc1
    v_fma_f32 v229, v229, s24, s24
    v_mfma_f32_16x16x32_bf16 v[82:85], v[166:169], v[214:217], v[82:85]
    ds_read_b128 v[142:145], v2 offset:30720
    ds_read_b128 v[146:149], v2 offset:31744
    v_mfma_f32_16x16x32_bf16 v[110:113], v[166:169], v[218:221], v[110:113]
    v_rcp_f32 v226, v226
    v_mfma_f32_16x16x32_bf16 v[86:89], v[170:173], v[214:217], v[86:89]
    ds_read_b128 v[150:153], v2 offset:32768
    ds_read_b128 v[154:157], v2 offset:33792
    v_mfma_f32_16x16x32_bf16 v[114:117], v[170:173], v[218:221], v[114:117]
    v_rcp_f32 v227, v227
    v_mfma_f32_16x16x32_bf16 v[90:93], v[174:177], v[214:217], v[90:93]
    ds_read_b128 v[158:161], v2 offset:34816
    buffer_load_dwordx4 v[206:209], v7, s[76:79], s88 offen offset:0 sc1
    v_mfma_f32_16x16x32_bf16 v[118:121], v[174:177], v[218:221], v[118:121]
    v_rcp_f32 v228, v228
    v_mfma_f32_16x16x32_bf16 v[94:97], v[178:181], v[214:217], v[94:97]
    buffer_load_dwordx4 v[210:213], v7, s[76:79], s88 offen offset:1024 sc1
    v_mul_f32 v62, v62, v226
    v_mfma_f32_16x16x32_bf16 v[122:125], v[178:181], v[218:221], v[122:125]
    buffer_load_dwordx4 a[144:147], v231, s[76:79], s84 offen offset:0 sc1
    v_mul_f32 v63, v63, v227
    v_mfma_f32_16x16x32_bf16 v[98:101], v[182:185], v[214:217], v[98:101]
    v_rcp_f32 v229, v229
    v_mfma_f32_16x16x32_bf16 v[126:129], v[182:185], v[218:221], v[126:129]
    v_exp_f32_e64 v222, -v66
    v_mfma_f32_16x16x32_bf16 v[102:105], v[186:189], v[214:217], v[102:105]
    v_exp_f32_e64 v223, -v67
    v_mfma_f32_16x16x32_bf16 v[130:133], v[186:189], v[218:221], v[130:133]
    v_mul_f32 v64, v64, v228
    s_waitcnt vmcnt(26) lgkmcnt(0)
    v_mfma_f32_16x16x32_bf16 v[78:81], v[134:137], a[224:227], v[78:81]
    ds_read_b128 v[162:165], v2 offset:35840
    ds_read_b128 v[166:169], v2 offset:36864
    v_mfma_f32_16x16x32_bf16 v[106:109], v[134:137], a[228:231], v[106:109]
    v_exp_f32_e64 v224, -v68
    v_mfma_f32_16x16x32_bf16 v[82:85], v[138:141], a[224:227], v[82:85]
    ds_read_b128 v[170:173], v2 offset:37888
    ds_read_b128 v[174:177], v2 offset:38912
    v_mfma_f32_16x16x32_bf16 v[110:113], v[138:141], a[228:231], v[110:113]
    buffer_load_dwordx4 a[148:151], v231, s[76:79], s84 offen offset:1024 sc1
    v_mul_f32 v65, v65, v229
    v_mfma_f32_16x16x32_bf16 v[86:89], v[142:145], a[224:227], v[86:89]
    ds_read_b128 v[178:181], v2 offset:39936
    ds_read_b128 v[182:185], v2 offset:40960
    v_mfma_f32_16x16x32_bf16 v[114:117], v[142:145], a[228:231], v[114:117]
    v_exp_f32_e64 v225, -v69
    v_mfma_f32_16x16x32_bf16 v[90:93], v[146:149], a[224:227], v[90:93]
    ds_read_b128 v[186:189], v2 offset:41984
    buffer_load_dwordx4 v[214:217], v7, s[76:79], s88 offen offset:2048 sc1
    v_mfma_f32_16x16x32_bf16 v[118:121], v[146:149], a[228:231], v[118:121]
    v_cvt_pk_bf16_f32 v52, v62, v63
    v_cvt_pk_bf16_f32 v53, v64, v65
    v_mfma_f32_16x16x32_bf16 v[94:97], v[150:153], a[224:227], v[94:97]
    buffer_load_dwordx4 v[218:221], v7, s[76:79], s88 offen offset:3072 sc1
    buffer_store_dwordx4 v[50:53], v10, s[76:79], 0 offen offset:256 sc1
    v_mfma_f32_16x16x32_bf16 v[122:125], v[150:153], a[228:231], v[122:125]
    buffer_load_dwordx4 a[152:155], v231, s[76:79], s84 offen offset:2048 sc1
    v_mul_f32 v70, v66, v70
    v_mfma_f32_16x16x32_bf16 v[98:101], v[154:157], a[224:227], v[98:101]
    v_mul_f32 v71, v67, v71
    v_mul_f32 v72, v68, v72
    v_mfma_f32_16x16x32_bf16 v[126:129], v[154:157], a[228:231], v[126:129]
    v_mul_f32 v73, v69, v73
    v_fma_f32 v222, v222, s24, s24
    v_mfma_f32_16x16x32_bf16 v[102:105], v[158:161], a[224:227], v[102:105]
    v_rcp_f32 v222, v222
    v_mfma_f32_16x16x32_bf16 v[130:133], v[158:161], a[228:231], v[130:133]
    v_fma_f32 v223, v223, s24, s24
    s_waitcnt vmcnt(27) lgkmcnt(0)
    v_mfma_f32_16x16x32_bf16 v[78:81], v[162:165], a[232:235], v[78:81]
    ds_read_b128 v[134:137], v2 offset:43008
    ds_read_b128 v[138:141], v2 offset:44032
    v_mfma_f32_16x16x32_bf16 v[106:109], v[162:165], a[236:239], v[106:109]
    v_rcp_f32 v223, v223
    v_mfma_f32_16x16x32_bf16 v[82:85], v[166:169], a[232:235], v[82:85]
    ds_read_b128 v[142:145], v2 offset:45056
    ds_read_b128 v[146:149], v2 offset:46080
    v_mfma_f32_16x16x32_bf16 v[110:113], v[166:169], a[236:239], v[110:113]
    buffer_load_dwordx4 a[156:159], v231, s[76:79], s84 offen offset:3072 sc1
    v_fma_f32 v224, v224, s24, s24
    v_mfma_f32_16x16x32_bf16 v[86:89], v[170:173], a[232:235], v[86:89]
    ds_read_b128 v[150:153], v2 offset:47104
    ds_read_b128 v[154:157], v2 offset:48128
    v_mfma_f32_16x16x32_bf16 v[114:117], v[170:173], a[236:239], v[114:117]
    v_rcp_f32 v224, v224
    v_mfma_f32_16x16x32_bf16 v[90:93], v[174:177], a[232:235], v[90:93]
    ds_read_b128 v[158:161], v2 offset:49152
    buffer_load_dwordx4 a[224:227], v7, s[76:79], s89 offen offset:0 sc1
    v_mfma_f32_16x16x32_bf16 v[118:121], v[174:177], a[236:239], v[118:121]
    v_exp_f32_e64 v226, -v74
    v_mfma_f32_16x16x32_bf16 v[94:97], v[178:181], a[232:235], v[94:97]
    buffer_load_dwordx4 a[228:231], v7, s[76:79], s89 offen offset:1024 sc1
    v_fma_f32 v225, v225, s24, s24
    v_mfma_f32_16x16x32_bf16 v[122:125], v[178:181], a[236:239], v[122:125]
    v_rcp_f32 v225, v225
    v_mfma_f32_16x16x32_bf16 v[98:101], v[182:185], a[232:235], v[98:101]
    buffer_load_dwordx4 a[160:163], v231, s[76:79], s85 offen offset:0 sc1
    v_mul_f32 v70, v70, v222
    v_mfma_f32_16x16x32_bf16 v[126:129], v[182:185], a[236:239], v[126:129]
    v_exp_f32_e64 v227, -v75
    v_mfma_f32_16x16x32_bf16 v[102:105], v[186:189], a[232:235], v[102:105]
    v_mul_f32 v71, v71, v223
    v_mul_f32 v72, v72, v224
    v_mfma_f32_16x16x32_bf16 v[130:133], v[186:189], a[236:239], v[130:133]
    v_mul_f32 v73, v73, v225
    s_waitcnt vmcnt(27) lgkmcnt(0)
    v_mfma_f32_16x16x32_bf16 v[78:81], v[134:137], a[240:243], v[78:81]
    ds_read_b128 v[162:165], v2 offset:50176
    ds_read_b128 v[166:169], v2 offset:51200
    v_mfma_f32_16x16x32_bf16 v[106:109], v[134:137], a[244:247], v[106:109]
    s_waitcnt vmcnt(25)
    v_cvt_pk_bf16_f32 v58, v70, v71
    v_mfma_f32_16x16x32_bf16 v[82:85], v[138:141], a[240:243], v[82:85]
    ds_read_b128 v[170:173], v2 offset:52224
    ds_read_b128 v[174:177], v2 offset:53248
    v_mfma_f32_16x16x32_bf16 v[110:113], v[138:141], a[244:247], v[110:113]
    buffer_load_dwordx4 a[164:167], v231, s[76:79], s85 offen offset:1024 sc1
    v_cvt_pk_bf16_f32 v59, v72, v73
    v_mfma_f32_16x16x32_bf16 v[86:89], v[142:145], a[240:243], v[86:89]
    ds_read_b128 v[178:181], v2 offset:54272
    ds_read_b128 v[182:185], v2 offset:55296
    v_mfma_f32_16x16x32_bf16 v[114:117], v[142:145], a[244:247], v[114:117]
    s_cmp_lg_u32 s11, 0
    s_cbranch_scc1 L33
    buffer_store_dword v4, v3, s[76:79], s97 offen offset:0
L34:
    v_mfma_f32_16x16x32_bf16 v[90:93], v[146:149], a[240:243], v[90:93]
    ds_read_b128 v[186:189], v2 offset:56320
    buffer_load_dwordx4 a[232:235], v7, s[76:79], s89 offen offset:2048 sc1
    v_mfma_f32_16x16x32_bf16 v[118:121], v[146:149], a[244:247], v[118:121]
    v_mul_f32 v76, v74, v76
    v_mul_f32 v77, v75, v77
    v_mfma_f32_16x16x32_bf16 v[94:97], v[150:153], a[240:243], v[94:97]
    buffer_load_dwordx4 a[236:239], v7, s[76:79], s89 offen offset:3072 sc1
    v_fma_f32 v226, v226, s24, s24
    v_mfma_f32_16x16x32_bf16 v[122:125], v[150:153], a[244:247], v[122:125]
    v_rcp_f32 v226, v226
    v_mfma_f32_16x16x32_bf16 v[98:101], v[154:157], a[240:243], v[98:101]
    buffer_load_dwordx4 a[168:171], v231, s[76:79], s85 offen offset:2048 sc1
    v_fma_f32 v227, v227, s24, s24
    v_mfma_f32_16x16x32_bf16 v[126:129], v[154:157], a[244:247], v[126:129]
    v_rcp_f32 v227, v227
    v_mfma_f32_16x16x32_bf16 v[102:105], v[158:161], a[240:243], v[102:105]
    v_mul_f32 v76, v76, v226
    v_mul_f32 v77, v77, v227
    v_mfma_f32_16x16x32_bf16 v[130:133], v[158:161], a[244:247], v[130:133]
    v_cvt_pk_bf16_f32 v60, v76, v77
    s_waitcnt vmcnt(26) lgkmcnt(0)
    v_mfma_f32_16x16x32_bf16 v[78:81], v[162:165], a[248:251], v[78:81]
    ds_read_b128 v[134:137], v19 offset:0
    ds_read_b128 v[138:141], v19 offset:1024
    v_mfma_f32_16x16x32_bf16 v[106:109], v[162:165], a[252:255], v[106:109]
    v_mov_b32 v55, v58
    v_mov_b32 v56, v59
    v_mfma_f32_16x16x32_bf16 v[82:85], v[166:169], a[248:251], v[82:85]
    ds_read_b128 v[142:145], v19 offset:2048
    ds_read_b128 v[146:149], v19 offset:3072
    v_mfma_f32_16x16x32_bf16 v[110:113], v[166:169], a[252:255], v[110:113]
    buffer_load_dwordx4 a[172:175], v231, s[76:79], s85 offen offset:3072 sc1
    v_mov_b32 v54, v60
    v_mfma_f32_16x16x32_bf16 v[86:89], v[170:173], a[248:251], v[86:89]
    ds_read_b128 v[150:153], v19 offset:4096
    ds_read_b128 v[154:157], v19 offset:5120
    v_mfma_f32_16x16x32_bf16 v[114:117], v[170:173], a[252:255], v[114:117]
    v_permlane32_swap_b32 v56, v61
    v_permlane32_swap_b32 v55, v54
    v_mfma_f32_16x16x32_bf16 v[90:93], v[174:177], a[248:251], v[90:93]
    ds_read_b128 v[158:161], v19 offset:6144
    buffer_load_dwordx4 a[240:243], v7, s[76:79], s90 offen offset:0 sc1
    v_mfma_f32_16x16x32_bf16 v[118:121], v[174:177], a[252:255], v[118:121]
    v_permlane16_swap_b32 v54, v61
    buffer_store_dwordx4 v[58:61], v11, s[76:79], 0 offen offset:256 sc1
    v_mfma_f32_16x16x32_bf16 v[94:97], v[178:181], a[248:251], v[94:97]
    buffer_load_dwordx4 a[244:247], v7, s[76:79], s90 offen offset:1024 sc1
    v_mfma_f32_16x16x32_bf16 v[122:125], v[178:181], a[252:255], v[122:125]
    v_mfma_f32_16x16x32_bf16 v[98:101], v[182:185], a[248:251], v[98:101]
    v_mfma_f32_16x16x32_bf16 v[126:129], v[182:185], a[252:255], v[126:129]
    buffer_load_dwordx4 a[176:179], v231, s[76:79], s86 offen offset:0 sc1
    v_mfma_f32_16x16x32_bf16 v[102:105], v[186:189], a[248:251], v[102:105]
    v_mfma_f32_16x16x32_bf16 v[130:133], v[186:189], a[252:255], v[130:133]
    s_waitcnt vmcnt(28) lgkmcnt(0)
    v_mfma_f32_16x16x32_bf16 v[78:81], v[134:137], v[190:193], v[78:81]
    ds_read_b128 v[162:165], v19 offset:7168
    ds_read_b128 v[166:169], v19 offset:8192
    v_mfma_f32_16x16x32_bf16 v[106:109], v[134:137], v[194:197], v[106:109]
    v_mfma_f32_16x16x32_bf16 v[82:85], v[138:141], v[190:193], v[82:85]
    ds_read_b128 v[170:173], v19 offset:9216
    ds_read_b128 v[174:177], v19 offset:10240
    v_mfma_f32_16x16x32_bf16 v[110:113], v[138:141], v[194:197], v[110:113]
    v_mfma_f32_16x16x32_bf16 v[86:89], v[142:145], v[190:193], v[86:89]
    ds_read_b128 v[178:181], v19 offset:11264
    ds_read_b128 v[182:185], v19 offset:12288
    v_mfma_f32_16x16x32_bf16 v[114:117], v[142:145], v[194:197], v[114:117]
    buffer_load_dwordx4 a[180:183], v231, s[76:79], s86 offen offset:1024 sc1
    v_mfma_f32_16x16x32_bf16 v[90:93], v[146:149], v[190:193], v[90:93]
    ds_read_b128 v[186:189], v19 offset:13312
    buffer_load_dwordx4 a[248:251], v7, s[76:79], s90 offen offset:2048 sc1
    v_mfma_f32_16x16x32_bf16 v[118:121], v[146:149], v[194:197], v[118:121]
    v_mfma_f32_16x16x32_bf16 v[94:97], v[150:153], v[190:193], v[94:97]
    buffer_load_dwordx4 a[252:255], v7, s[76:79], s90 offen offset:3072 sc1
    v_mfma_f32_16x16x32_bf16 v[122:125], v[150:153], v[194:197], v[122:125]
    v_mfma_f32_16x16x32_bf16 v[98:101], v[154:157], v[190:193], v[98:101]
    v_mfma_f32_16x16x32_bf16 v[126:129], v[154:157], v[194:197], v[126:129]
    buffer_load_dwordx4 a[184:187], v231, s[76:79], s86 offen offset:2048 sc1
    v_mfma_f32_16x16x32_bf16 v[102:105], v[158:161], v[190:193], v[102:105]
    buffer_load_dword v5, v18, s[76:79], s96 offen offset:0 sc1
    v_mfma_f32_16x16x32_bf16 v[130:133], v[158:161], v[194:197], v[130:133]
    s_waitcnt vmcnt(29) lgkmcnt(0)
    v_mfma_f32_16x16x32_bf16 v[78:81], v[162:165], v[198:201], v[78:81]
    ds_read_b128 v[134:137], v19 offset:14336
    ds_read_b128 v[138:141], v19 offset:15360
    v_mfma_f32_16x16x32_bf16 v[106:109], v[162:165], v[202:205], v[106:109]
    v_mfma_f32_16x16x32_bf16 v[82:85], v[166:169], v[198:201], v[82:85]
    ds_read_b128 v[142:145], v19 offset:16384
    ds_read_b128 v[146:149], v19 offset:17408
    v_mfma_f32_16x16x32_bf16 v[110:113], v[166:169], v[202:205], v[110:113]
    v_mfma_f32_16x16x32_bf16 v[86:89], v[170:173], v[198:201], v[86:89]
    ds_read_b128 v[150:153], v19 offset:18432
    ds_read_b128 v[154:157], v19 offset:19456
    v_mfma_f32_16x16x32_bf16 v[114:117], v[170:173], v[202:205], v[114:117]
    buffer_load_dwordx4 a[188:191], v231, s[76:79], s86 offen offset:3072 sc1
    v_mfma_f32_16x16x32_bf16 v[90:93], v[174:177], v[198:201], v[90:93]
    ds_read_b128 v[158:161], v19 offset:20480
    v_mfma_f32_16x16x32_bf16 v[118:121], v[174:177], v[202:205], v[118:121]
    v_mfma_f32_16x16x32_bf16 v[94:97], v[178:181], v[198:201], v[94:97]
    v_mfma_f32_16x16x32_bf16 v[122:125], v[178:181], v[202:205], v[122:125]
    v_mfma_f32_16x16x32_bf16 v[98:101], v[182:185], v[198:201], v[98:101]
    v_mfma_f32_16x16x32_bf16 v[126:129], v[182:185], v[202:205], v[126:129]
    v_mfma_f32_16x16x32_bf16 v[102:105], v[186:189], v[198:201], v[102:105]
    buffer_load_dwordx4 a[192:195], v231, s[76:79], s87 offen offset:0 sc1
    v_mfma_f32_16x16x32_bf16 v[130:133], v[186:189], v[202:205], v[130:133]
    s_waitcnt vmcnt(27) lgkmcnt(0)
    v_mfma_f32_16x16x32_bf16 v[78:81], v[134:137], v[206:209], v[78:81]
    ds_read_b128 v[162:165], v19 offset:21504
    ds_read_b128 v[166:169], v19 offset:22528
    v_mfma_f32_16x16x32_bf16 v[106:109], v[134:137], v[210:213], v[106:109]
    v_mfma_f32_16x16x32_bf16 v[82:85], v[138:141], v[206:209], v[82:85]
    ds_read_b128 v[170:173], v19 offset:23552
    ds_read_b128 v[174:177], v19 offset:24576
    v_mfma_f32_16x16x32_bf16 v[110:113], v[138:141], v[210:213], v[110:113]
    v_mfma_f32_16x16x32_bf16 v[86:89], v[142:145], v[206:209], v[86:89]
    ds_read_b128 v[178:181], v19 offset:25600
    ds_read_b128 v[182:185], v19 offset:26624
    v_mfma_f32_16x16x32_bf16 v[114:117], v[142:145], v[210:213], v[114:117]
    buffer_load_dwordx4 a[196:199], v231, s[76:79], s87 offen offset:1024 sc1
    v_mfma_f32_16x16x32_bf16 v[90:93], v[146:149], v[206:209], v[90:93]
    ds_read_b128 v[186:189], v19 offset:27648
    v_mfma_f32_16x16x32_bf16 v[118:121], v[146:149], v[210:213], v[118:121]
    v_mfma_f32_16x16x32_bf16 v[94:97], v[150:153], v[206:209], v[94:97]
    v_mfma_f32_16x16x32_bf16 v[122:125], v[150:153], v[210:213], v[122:125]
    v_mfma_f32_16x16x32_bf16 v[98:101], v[154:157], v[206:209], v[98:101]
    v_mfma_f32_16x16x32_bf16 v[126:129], v[154:157], v[210:213], v[126:129]
    v_mfma_f32_16x16x32_bf16 v[102:105], v[158:161], v[206:209], v[102:105]
    buffer_load_dwordx4 a[200:203], v231, s[76:79], s87 offen offset:2048 sc1
    s_waitcnt vmcnt(4)
    v_mfma_f32_16x16x32_bf16 v[130:133], v[158:161], v[210:213], v[130:133]
    v_cmp_ne_u32 vcc, s8, v5
    s_waitcnt lgkmcnt(0)
    v_mfma_f32_16x16x32_bf16 v[78:81], v[162:165], v[214:217], v[78:81]
    ds_read_b128 v[134:137], v19 offset:28672
    ds_read_b128 v[138:141], v19 offset:29696
    v_mfma_f32_16x16x32_bf16 v[106:109], v[162:165], v[218:221], v[106:109]
    s_cbranch_vccnz L30
L31:
    buffer_load_dwordx4 v[22:25], v8, s[76:79], 0 offen offset:0 sc1
    v_mfma_f32_16x16x32_bf16 v[82:85], v[166:169], v[214:217], v[82:85]
    ds_read_b128 v[142:145], v19 offset:30720
    ds_read_b128 v[146:149], v19 offset:31744
    v_mfma_f32_16x16x32_bf16 v[110:113], v[166:169], v[218:221], v[110:113]
    buffer_load_dwordx4 v[26:29], v8, s[76:79], 0 offen offset:2048 sc1
    v_mfma_f32_16x16x32_bf16 v[86:89], v[170:173], v[214:217], v[86:89]
    ds_read_b128 v[150:153], v19 offset:32768
    ds_read_b128 v[154:157], v19 offset:33792
    v_mfma_f32_16x16x32_bf16 v[114:117], v[170:173], v[218:221], v[114:117]
    buffer_load_dwordx4 a[204:207], v231, s[76:79], s87 offen offset:3072 sc1
    v_mfma_f32_16x16x32_bf16 v[90:93], v[174:177], v[214:217], v[90:93]
    ds_read_b128 v[158:161], v19 offset:34816
    buffer_load_dwordx4 v[30:33], v8, s[76:79], s84 offen offset:0 sc1
    v_mfma_f32_16x16x32_bf16 v[118:121], v[174:177], v[218:221], v[118:121]
    v_mfma_f32_16x16x32_bf16 v[94:97], v[178:181], v[214:217], v[94:97]
    v_mfma_f32_16x16x32_bf16 v[122:125], v[178:181], v[218:221], v[122:125]
    v_mfma_f32_16x16x32_bf16 v[98:101], v[182:185], v[214:217], v[98:101]
    buffer_load_dwordx4 v[34:37], v8, s[76:79], s84 offen offset:2048 sc1
    v_mfma_f32_16x16x32_bf16 v[126:129], v[182:185], v[218:221], v[126:129]
    v_mfma_f32_16x16x32_bf16 v[102:105], v[186:189], v[214:217], v[102:105]
    v_mfma_f32_16x16x32_bf16 v[130:133], v[186:189], v[218:221], v[130:133]
    buffer_load_dwordx4 a[208:211], v231, s[76:79], s88 offen offset:0 sc1
    s_waitcnt lgkmcnt(0)
    v_mfma_f32_16x16x32_bf16 v[78:81], v[134:137], a[224:227], v[78:81]
    ds_read_b128 v[162:165], v19 offset:35840
    ds_read_b128 v[166:169], v19 offset:36864
    v_mfma_f32_16x16x32_bf16 v[106:109], v[134:137], a[228:231], v[106:109]
    buffer_load_dwordx4 v[38:41], v8, s[76:79], s85 offen offset:0 sc1
    v_mfma_f32_16x16x32_bf16 v[82:85], v[138:141], a[224:227], v[82:85]
    ds_read_b128 v[170:173], v19 offset:37888
    ds_read_b128 v[174:177], v19 offset:38912
    v_mfma_f32_16x16x32_bf16 v[110:113], v[138:141], a[228:231], v[110:113]
    v_mfma_f32_16x16x32_bf16 v[86:89], v[142:145], a[224:227], v[86:89]
    ds_read_b128 v[178:181], v19 offset:39936
    ds_read_b128 v[182:185], v19 offset:40960
    v_mfma_f32_16x16x32_bf16 v[114:117], v[142:145], a[228:231], v[114:117]
    buffer_load_dwordx4 v[42:45], v8, s[76:79], s85 offen offset:2048 sc1
    v_mfma_f32_16x16x32_bf16 v[90:93], v[146:149], a[224:227], v[90:93]
    ds_read_b128 v[186:189], v19 offset:41984
    buffer_load_dwordx4 a[212:215], v231, s[76:79], s88 offen offset:1024 sc1
    v_mfma_f32_16x16x32_bf16 v[118:121], v[146:149], a[228:231], v[118:121]
    v_mfma_f32_16x16x32_bf16 v[94:97], v[150:153], a[224:227], v[94:97]
    buffer_load_dwordx4 v[46:49], v8, s[76:79], s86 offen offset:0 sc1
    v_mfma_f32_16x16x32_bf16 v[122:125], v[150:153], a[228:231], v[122:125]
    v_mfma_f32_16x16x32_bf16 v[98:101], v[154:157], a[224:227], v[98:101]
    v_mfma_f32_16x16x32_bf16 v[126:129], v[154:157], a[228:231], v[126:129]
    v_mfma_f32_16x16x32_bf16 v[102:105], v[158:161], a[224:227], v[102:105]
    v_mfma_f32_16x16x32_bf16 v[130:133], v[158:161], a[228:231], v[130:133]
    buffer_load_dwordx4 a[216:219], v231, s[76:79], s88 offen offset:2048 sc1
    s_waitcnt lgkmcnt(0)
    v_mfma_f32_16x16x32_bf16 v[78:81], v[162:165], a[232:235], v[78:81]
    ds_read_b128 v[134:137], v19 offset:43008
    ds_read_b128 v[138:141], v19 offset:44032
    v_mfma_f32_16x16x32_bf16 v[106:109], v[162:165], a[236:239], v[106:109]
    v_mfma_f32_16x16x32_bf16 v[82:85], v[166:169], a[232:235], v[82:85]
    ds_read_b128 v[142:145], v19 offset:45056
    ds_read_b128 v[146:149], v19 offset:46080
    v_mfma_f32_16x16x32_bf16 v[110:113], v[166:169], a[236:239], v[110:113]
    s_cmp_lg_u32 s11, 0
    s_cbranch_scc1 L35
    buffer_store_dword v4, v3, s[76:79], s97 offen offset:512
L36:
    v_mfma_f32_16x16x32_bf16 v[86:89], v[170:173], a[232:235], v[86:89]
    ds_read_b128 v[150:153], v19 offset:47104
    ds_read_b128 v[154:157], v19 offset:48128
    v_mfma_f32_16x16x32_bf16 v[114:117], v[170:173], a[236:239], v[114:117]
    buffer_load_dwordx4 v[50:53], v8, s[76:79], s86 offen offset:2048 sc1
    v_mfma_f32_16x16x32_bf16 v[90:93], v[174:177], a[232:235], v[90:93]
    ds_read_b128 v[158:161], v19 offset:49152
    buffer_load_dwordx4 a[220:223], v231, s[76:79], s88 offen offset:3072 sc1
    v_mfma_f32_16x16x32_bf16 v[118:121], v[174:177], a[236:239], v[118:121]
    v_mfma_f32_16x16x32_bf16 v[94:97], v[178:181], a[232:235], v[94:97]
    buffer_load_dwordx4 v[54:57], v8, s[76:79], s87 offen offset:0 sc1
    v_mfma_f32_16x16x32_bf16 v[122:125], v[178:181], a[236:239], v[122:125]
    v_mfma_f32_16x16x32_bf16 v[98:101], v[182:185], a[232:235], v[98:101]
    v_mfma_f32_16x16x32_bf16 v[126:129], v[182:185], a[236:239], v[126:129]
    v_mfma_f32_16x16x32_bf16 v[102:105], v[186:189], a[232:235], v[102:105]
    buffer_load_dwordx4 v[58:61], v8, s[76:79], s87 offen offset:2048 sc1
    v_mfma_f32_16x16x32_bf16 v[130:133], v[186:189], a[236:239], v[130:133]
    s_waitcnt lgkmcnt(0)
    v_mfma_f32_16x16x32_bf16 v[78:81], v[134:137], a[240:243], v[78:81]
    ds_read_b128 v[162:165], v19 offset:50176
    ds_read_b128 v[166:169], v19 offset:51200
    v_mfma_f32_16x16x32_bf16 v[106:109], v[134:137], a[244:247], v[106:109]
    v_mfma_f32_16x16x32_bf16 v[82:85], v[138:141], a[240:243], v[82:85]
    ds_read_b128 v[170:173], v19 offset:52224
    ds_read_b128 v[174:177], v19 offset:53248
    v_mfma_f32_16x16x32_bf16 v[110:113], v[138:141], a[244:247], v[110:113]
    buffer_load_dwordx4 v[62:65], v8, s[76:79], s88 offen offset:0 sc1
    v_mfma_f32_16x16x32_bf16 v[86:89], v[142:145], a[240:243], v[86:89]
    ds_read_b128 v[178:181], v19 offset:54272
    ds_read_b128 v[182:185], v19 offset:55296
    v_mfma_f32_16x16x32_bf16 v[114:117], v[142:145], a[244:247], v[114:117]
    v_mfma_f32_16x16x32_bf16 v[90:93], v[146:149], a[240:243], v[90:93]
    ds_read_b128 v[186:189], v19 offset:56320
    buffer_load_dwordx4 v[66:69], v8, s[76:79], s88 offen offset:2048 sc1
    v_mfma_f32_16x16x32_bf16 v[118:121], v[146:149], a[244:247], v[118:121]
    v_mfma_f32_16x16x32_bf16 v[94:97], v[150:153], a[240:243], v[94:97]
    v_mfma_f32_16x16x32_bf16 v[122:125], v[150:153], a[244:247], v[122:125]
    v_mfma_f32_16x16x32_bf16 v[98:101], v[154:157], a[240:243], v[98:101]
    buffer_load_dwordx4 v[70:73], v8, s[76:79], s89 offen offset:0 sc1
    v_mfma_f32_16x16x32_bf16 v[126:129], v[154:157], a[244:247], v[126:129]
    v_mfma_f32_16x16x32_bf16 v[102:105], v[158:161], a[240:243], v[102:105]
    v_mfma_f32_16x16x32_bf16 v[130:133], v[158:161], a[244:247], v[130:133]
    s_waitcnt lgkmcnt(0)
    v_mfma_f32_16x16x32_bf16 v[78:81], v[162:165], a[248:251], v[78:81]
    buffer_load_dwordx4 v[74:77], v8, s[76:79], s89 offen offset:2048 sc1
    v_mfma_f32_16x16x32_bf16 v[106:109], v[162:165], a[252:255], v[106:109]
    v_mfma_f32_16x16x32_bf16 v[82:85], v[166:169], a[248:251], v[82:85]
    v_mfma_f32_16x16x32_bf16 v[110:113], v[166:169], a[252:255], v[110:113]
    v_mfma_f32_16x16x32_bf16 v[86:89], v[170:173], a[248:251], v[86:89]
    v_mfma_f32_16x16x32_bf16 v[114:117], v[170:173], a[252:255], v[114:117]
    v_mfma_f32_16x16x32_bf16 v[90:93], v[174:177], a[248:251], v[90:93]
    v_mfma_f32_16x16x32_bf16 v[118:121], v[174:177], a[252:255], v[118:121]
    v_mfma_f32_16x16x32_bf16 v[94:97], v[178:181], a[248:251], v[94:97]
    v_mfma_f32_16x16x32_bf16 v[122:125], v[178:181], a[252:255], v[122:125]
    v_mfma_f32_16x16x32_bf16 v[98:101], v[182:185], a[248:251], v[98:101]
    v_mfma_f32_16x16x32_bf16 v[126:129], v[182:185], a[252:255], v[126:129]
    v_mfma_f32_16x16x32_bf16 v[102:105], v[186:189], a[248:251], v[102:105]
    v_mfma_f32_16x16x32_bf16 v[130:133], v[186:189], a[252:255], v[130:133]
    v_exp_f32_e64 v222, -v78
    v_pk_mul_f32 v[82:83], v[78:79], v[82:83]
    v_exp_f32_e64 v223, -v79
    v_pk_mul_f32 v[84:85], v[80:81], v[84:85]
    v_exp_f32_e64 v224, -v80
    v_pk_fma_f32 v[222:223], v[222:223], s[24:25], s[24:25]
    v_exp_f32_e64 v225, -v81
    v_rcp_f32 v222, v222
    v_pk_fma_f32 v[224:225], v[224:225], s[24:25], s[24:25]
    v_rcp_f32 v223, v223
    v_pk_mul_f32 v[90:91], v[86:87], v[90:91]
    v_rcp_f32 v224, v224
    v_pk_mul_f32 v[82:83], v[82:83], v[222:223]
    v_rcp_f32 v225, v225
    v_cvt_pk_bf16_f32 v78, v82, v83
    v_pk_mul_f32 v[84:85], v[84:85], v[224:225]
    v_exp_f32_e64 v226, -v86
    v_cvt_pk_bf16_f32 v79, v84, v85
    v_exp_f32_e64 v227, -v87
    v_exp_f32_e64 v228, -v88
    v_pk_mul_f32 v[92:93], v[88:89], v[92:93]
    v_exp_f32_e64 v229, -v89
    v_pk_fma_f32 v[226:227], v[226:227], s[24:25], s[24:25]
    v_pk_fma_f32 v[228:229], v[228:229], s[24:25], s[24:25]
    v_rcp_f32 v226, v226
    v_rcp_f32 v227, v227
    v_pk_mul_f32 v[98:99], v[94:95], v[98:99]
    v_rcp_f32 v228, v228
    v_pk_mul_f32 v[90:91], v[90:91], v[226:227]
    v_rcp_f32 v229, v229
    v_cvt_pk_bf16_f32 v80, v90, v91
    v_pk_mul_f32 v[92:93], v[92:93], v[228:229]
    v_exp_f32_e64 v222, -v94
    v_cvt_pk_bf16_f32 v81, v92, v93
    v_exp_f32_e64 v223, -v95
    buffer_store_dwordx4 v[78:81], v10, s[76:79], s91 offen offset:0 sc1
    v_exp_f32_e64 v224, -v96
    v_exp_f32_e64 v225, -v97
    v_pk_mul_f32 v[100:101], v[96:97], v[100:101]
    v_pk_fma_f32 v[222:223], v[222:223], s[24:25], s[24:25]
    v_rcp_f32 v222, v222
    buffer_load_dword v5, v18, s[76:79], s96 offen offset:512 sc1
    v_pk_fma_f32 v[224:225], v[224:225], s[24:25], s[24:25]
    v_rcp_f32 v223, v223
    v_rcp_f32 v224, v224
    v_pk_mul_f32 v[98:99], v[98:99], v[222:223]
    v_rcp_f32 v225, v225
    v_cvt_pk_bf16_f32 v86, v98, v99
    v_pk_mul_f32 v[100:101], v[100:101], v[224:225]
    v_exp_f32_e64 v226, -v102
    v_cvt_pk_bf16_f32 v87, v100, v101
    v_exp_f32_e64 v227, -v103
    v_pk_mul_f32 v[104:105], v[102:103], v[104:105]
    v_pk_fma_f32 v[226:227], v[226:227], s[24:25], s[24:25]
    v_mov_b32 v83, v86
    v_rcp_f32 v226, v226
    v_mov_b32 v84, v87
    v_rcp_f32 v227, v227
    v_pk_mul_f32 v[110:111], v[106:107], v[110:111]
    v_pk_mul_f32 v[104:105], v[104:105], v[226:227]
    v_exp_f32_e64 v222, -v106
    v_cvt_pk_bf16_f32 v88, v104, v105
    v_exp_f32_e64 v223, -v107
    v_mov_b32 v82, v88
    v_exp_f32_e64 v224, -v108
    v_permlane32_swap_b32 v84, v89
    v_exp_f32_e64 v225, -v109
    v_permlane32_swap_b32 v83, v82
    v_pk_mul_f32 v[112:113], v[108:109], v[112:113]
    v_pk_fma_f32 v[222:223], v[222:223], s[24:25], s[24:25]
    v_permlane16_swap_b32 v82, v89
    v_rcp_f32 v222, v222
    buffer_store_dwordx4 v[86:89], v11, s[76:79], s91 offen offset:0 sc1
    v_rcp_f32 v223, v223
    v_pk_fma_f32 v[224:225], v[224:225], s[24:25], s[24:25]
    v_rcp_f32 v224, v224
    v_rcp_f32 v225, v225
    v_pk_mul_f32 v[110:111], v[110:111], v[222:223]
    v_pk_mul_f32 v[112:113], v[112:113], v[224:225]
    v_exp_f32_e64 v226, -v114
    v_cvt_pk_bf16_f32 v106, v110, v111
    v_exp_f32_e64 v227, -v115
    v_cvt_pk_bf16_f32 v107, v112, v113
    v_exp_f32_e64 v228, -v116
    v_exp_f32_e64 v229, -v117
    v_pk_mul_f32 v[118:119], v[114:115], v[118:119]
    v_pk_mul_f32 v[120:121], v[116:117], v[120:121]
    v_exp_f32_e64 v222, -v122
    v_pk_fma_f32 v[226:227], v[226:227], s[24:25], s[24:25]
    v_rcp_f32 v226, v226
    v_pk_fma_f32 v[228:229], v[228:229], s[24:25], s[24:25]
    v_rcp_f32 v227, v227
    v_rcp_f32 v228, v228
    v_pk_mul_f32 v[118:119], v[118:119], v[226:227]
    v_rcp_f32 v229, v229
    v_cvt_pk_bf16_f32 v108, v118, v119
    v_pk_mul_f32 v[120:121], v[120:121], v[228:229]
    v_exp_f32_e64 v223, -v123
    v_cvt_pk_bf16_f32 v109, v120, v121
    v_exp_f32_e64 v224, -v124
    buffer_store_dwordx4 v[106:109], v10, s[76:79], s91 offen offset:256 sc1
    v_exp_f32_e64 v225, -v125
    v_pk_mul_f32 v[126:127], v[122:123], v[126:127]
    v_exp_f32_e64 v226, -v130
    v_pk_mul_f32 v[128:129], v[124:125], v[128:129]
    v_exp_f32_e64 v227, -v131
    v_pk_fma_f32 v[222:223], v[222:223], s[24:25], s[24:25]
    v_rcp_f32 v222, v222
    v_pk_fma_f32 v[224:225], v[224:225], s[24:25], s[24:25]
    v_rcp_f32 v223, v223
    v_rcp_f32 v224, v224
    v_pk_mul_f32 v[126:127], v[126:127], v[222:223]
    v_rcp_f32 v225, v225
    v_cvt_pk_bf16_f32 v114, v126, v127
    v_pk_mul_f32 v[128:129], v[128:129], v[224:225]
    v_cvt_pk_bf16_f32 v115, v128, v129
    v_pk_mul_f32 v[132:133], v[130:131], v[132:133]
    v_pk_fma_f32 v[226:227], v[226:227], s[24:25], s[24:25]
    v_rcp_f32 v226, v226
    v_rcp_f32 v227, v227
    v_mov_b32 v111, v114
    v_pk_mul_f32 v[132:133], v[132:133], v[226:227]
    v_cvt_pk_bf16_f32 v116, v132, v133
    v_mov_b32 v112, v115
    v_mov_b32 v110, v116
    s_nop 0
    v_permlane32_swap_b32 v112, v117
    v_permlane32_swap_b32 v111, v110
    s_nop 1
    v_permlane16_swap_b32 v110, v117
    buffer_store_dwordx4 v[114:117], v11, s[76:79], s91 offen offset:256 sc1
    s_waitcnt vmcnt(11)
    v_mfma_f32_16x16x32_bf16 v[190:193], a[0:3], v[22:25], 0
    s_waitcnt vmcnt(3)
    v_cmp_ne_u32 vcc, s8, v5
    v_mfma_f32_16x16x32_bf16 v[194:197], a[4:7], v[22:25], 0
    s_cbranch_vccnz L37
L38:
    v_mfma_f32_16x16x32_bf16 v[198:201], a[8:11], v[22:25], 0
    v_mfma_f32_16x16x32_bf16 v[202:205], a[12:15], v[22:25], 0
    v_mfma_f32_16x16x32_bf16 v[190:193], a[16:19], v[26:29], v[190:193]
    buffer_load_dwordx4 v[134:137], v8, s[76:79], 0 offen offset:256 sc1
    v_mfma_f32_16x16x32_bf16 v[194:197], a[20:23], v[26:29], v[194:197]
    v_mfma_f32_16x16x32_bf16 v[198:201], a[24:27], v[26:29], v[198:201]
    v_mfma_f32_16x16x32_bf16 v[202:205], a[28:31], v[26:29], v[202:205]
    v_mfma_f32_16x16x32_bf16 v[190:193], a[32:35], v[30:33], v[190:193]
    buffer_load_dwordx4 v[138:141], v8, s[76:79], 0 offen offset:2304 sc1
    v_mfma_f32_16x16x32_bf16 v[194:197], a[36:39], v[30:33], v[194:197]
    v_mfma_f32_16x16x32_bf16 v[198:201], a[40:43], v[30:33], v[198:201]
    v_mfma_f32_16x16x32_bf16 v[202:205], a[44:47], v[30:33], v[202:205]
    v_mfma_f32_16x16x32_bf16 v[190:193], a[48:51], v[34:37], v[190:193]
    buffer_load_dwordx4 v[142:145], v8, s[76:79], s84 offen offset:256 sc1
    v_mfma_f32_16x16x32_bf16 v[194:197], a[52:55], v[34:37], v[194:197]
    v_mfma_f32_16x16x32_bf16 v[198:201], a[56:59], v[34:37], v[198:201]
    v_mfma_f32_16x16x32_bf16 v[202:205], a[60:63], v[34:37], v[202:205]
    v_mfma_f32_16x16x32_bf16 v[190:193], a[64:67], v[38:41], v[190:193]
    buffer_load_dwordx4 v[146:149], v8, s[76:79], s84 offen offset:2304 sc1
    v_mfma_f32_16x16x32_bf16 v[194:197], a[68:71], v[38:41], v[194:197]
    v_mfma_f32_16x16x32_bf16 v[198:201], a[72:75], v[38:41], v[198:201]
    v_mfma_f32_16x16x32_bf16 v[202:205], a[76:79], v[38:41], v[202:205]
    v_mfma_f32_16x16x32_bf16 v[190:193], a[80:83], v[42:45], v[190:193]
    buffer_load_dwordx4 v[150:153], v8, s[76:79], s85 offen offset:256 sc1
    v_mfma_f32_16x16x32_bf16 v[194:197], a[84:87], v[42:45], v[194:197]
    s_waitcnt vmcnt(7)
    v_mfma_f32_16x16x32_bf16 v[198:201], a[88:91], v[42:45], v[198:201]
    s_cmp_lg_u32 s11, 0
    s_cbranch_scc1 L46
    buffer_store_dword v4, v3, s[76:79], s97 offen offset:1024
L47:
    v_mfma_f32_16x16x32_bf16 v[202:205], a[92:95], v[42:45], v[202:205]
    v_mfma_f32_16x16x32_bf16 v[190:193], a[96:99], v[46:49], v[190:193]
    buffer_load_dwordx4 v[154:157], v8, s[76:79], s85 offen offset:2304 sc1
    v_mfma_f32_16x16x32_bf16 v[194:197], a[100:103], v[46:49], v[194:197]
    v_mfma_f32_16x16x32_bf16 v[198:201], a[104:107], v[46:49], v[198:201]
    v_mfma_f32_16x16x32_bf16 v[202:205], a[108:111], v[46:49], v[202:205]
    v_mfma_f32_16x16x32_bf16 v[190:193], a[112:115], v[50:53], v[190:193]
    buffer_load_dwordx4 v[158:161], v8, s[76:79], s86 offen offset:256 sc1
    v_mfma_f32_16x16x32_bf16 v[194:197], a[116:119], v[50:53], v[194:197]
    v_mfma_f32_16x16x32_bf16 v[198:201], a[120:123], v[50:53], v[198:201]
    v_mfma_f32_16x16x32_bf16 v[202:205], a[124:127], v[50:53], v[202:205]
    v_mfma_f32_16x16x32_bf16 v[190:193], a[128:131], v[54:57], v[190:193]
    buffer_load_dwordx4 v[162:165], v8, s[76:79], s86 offen offset:2304 sc1
    v_mfma_f32_16x16x32_bf16 v[194:197], a[132:135], v[54:57], v[194:197]
    v_mfma_f32_16x16x32_bf16 v[198:201], a[136:139], v[54:57], v[198:201]
    v_mfma_f32_16x16x32_bf16 v[202:205], a[140:143], v[54:57], v[202:205]
    v_mfma_f32_16x16x32_bf16 v[190:193], a[144:147], v[58:61], v[190:193]
    buffer_load_dwordx4 v[166:169], v8, s[76:79], s87 offen offset:256 sc1
    v_mfma_f32_16x16x32_bf16 v[194:197], a[148:151], v[58:61], v[194:197]
    v_mfma_f32_16x16x32_bf16 v[198:201], a[152:155], v[58:61], v[198:201]
    v_mfma_f32_16x16x32_bf16 v[202:205], a[156:159], v[58:61], v[202:205]
    v_mfma_f32_16x16x32_bf16 v[190:193], a[160:163], v[62:65], v[190:193]
    buffer_load_dwordx4 v[170:173], v8, s[76:79], s87 offen offset:2304 sc1
    v_mfma_f32_16x16x32_bf16 v[194:197], a[164:167], v[62:65], v[194:197]
    v_mfma_f32_16x16x32_bf16 v[198:201], a[168:171], v[62:65], v[198:201]
    v_mfma_f32_16x16x32_bf16 v[202:205], a[172:175], v[62:65], v[202:205]
    v_mfma_f32_16x16x32_bf16 v[190:193], a[176:179], v[66:69], v[190:193]
    buffer_load_dwordx4 v[174:177], v8, s[76:79], s88 offen offset:256 sc1
    v_mfma_f32_16x16x32_bf16 v[194:197], a[180:183], v[66:69], v[194:197]
    v_mfma_f32_16x16x32_bf16 v[198:201], a[184:187], v[66:69], v[198:201]
    v_mfma_f32_16x16x32_bf16 v[202:205], a[188:191], v[66:69], v[202:205]
    v_mfma_f32_16x16x32_bf16 v[190:193], a[192:195], v[70:73], v[190:193]
    buffer_load_dwordx4 v[178:181], v8, s[76:79], s88 offen offset:2304 sc1
    v_mfma_f32_16x16x32_bf16 v[194:197], a[196:199], v[70:73], v[194:197]
    buffer_load_dword v5, v18, s[76:79], s96 offen offset:1024 sc1
    v_mfma_f32_16x16x32_bf16 v[198:201], a[200:203], v[70:73], v[198:201]
    s_waitcnt vmcnt(14)
    v_mfma_f32_16x16x32_bf16 v[202:205], a[204:207], v[70:73], v[202:205]
    s_cmp_lg_u32 s11, 0
    s_cbranch_scc1 L48
    buffer_store_dword v4, v3, s[76:79], s97 offen offset:1536
L49:
    v_mfma_f32_16x16x32_bf16 v[190:193], a[208:211], v[74:77], v[190:193]
    buffer_load_dwordx4 v[182:185], v8, s[76:79], s89 offen offset:256 sc1
    v_mfma_f32_16x16x32_bf16 v[194:197], a[212:215], v[74:77], v[194:197]
    v_mfma_f32_16x16x32_bf16 v[198:201], a[216:219], v[74:77], v[198:201]
    v_mfma_f32_16x16x32_bf16 v[202:205], a[220:223], v[74:77], v[202:205]
    s_waitcnt vmcnt(14)
    v_mfma_f32_16x16x32_bf16 v[206:209], a[0:3], v[134:137], 0
    buffer_load_dwordx4 v[186:189], v8, s[76:79], s89 offen offset:2304 sc1
    v_mfma_f32_16x16x32_bf16 v[210:213], a[4:7], v[134:137], 0
    v_mfma_f32_16x16x32_bf16 v[214:217], a[8:11], v[134:137], 0
    v_mfma_f32_16x16x32_bf16 v[218:221], a[12:15], v[134:137], 0
    v_mfma_f32_16x16x32_bf16 v[206:209], a[16:19], v[138:141], v[206:209]
    v_mfma_f32_16x16x32_bf16 v[210:213], a[20:23], v[138:141], v[210:213]
    v_mfma_f32_16x16x32_bf16 v[214:217], a[24:27], v[138:141], v[214:217]
    v_mfma_f32_16x16x32_bf16 v[218:221], a[28:31], v[138:141], v[218:221]
    s_waitcnt vmcnt(13)
    v_mfma_f32_16x16x32_bf16 v[206:209], a[32:35], v[142:145], v[206:209]
    v_mfma_f32_16x16x32_bf16 v[210:213], a[36:39], v[142:145], v[210:213]
    v_mfma_f32_16x16x32_bf16 v[214:217], a[40:43], v[142:145], v[214:217]
    v_mfma_f32_16x16x32_bf16 v[218:221], a[44:47], v[142:145], v[218:221]
    v_mfma_f32_16x16x32_bf16 v[206:209], a[48:51], v[146:149], v[206:209]
    v_mfma_f32_16x16x32_bf16 v[210:213], a[52:55], v[146:149], v[210:213]
    v_mfma_f32_16x16x32_bf16 v[214:217], a[56:59], v[146:149], v[214:217]
    v_mfma_f32_16x16x32_bf16 v[218:221], a[60:63], v[146:149], v[218:221]
    s_waitcnt vmcnt(10)
    v_mfma_f32_16x16x32_bf16 v[206:209], a[64:67], v[150:153], v[206:209]
    v_mfma_f32_16x16x32_bf16 v[210:213], a[68:71], v[150:153], v[210:213]
    v_mfma_f32_16x16x32_bf16 v[214:217], a[72:75], v[150:153], v[214:217]
    s_waitcnt vmcnt(3)
    v_cmp_ne_u32 vcc, s8, v5
    v_mfma_f32_16x16x32_bf16 v[218:221], a[76:79], v[150:153], v[218:221]
    s_cbranch_vccnz L40
L41:
    v_mfma_f32_16x16x32_bf16 v[206:209], a[80:83], v[154:157], v[206:209]
    buffer_load_dwordx4 v[78:81], v9, s[76:79], 0 offen offset:0 sc1
    v_mfma_f32_16x16x32_bf16 v[210:213], a[84:87], v[154:157], v[210:213]
    v_mfma_f32_16x16x32_bf16 v[214:217], a[88:91], v[154:157], v[214:217]
    buffer_load_dword v5, v18, s[76:79], s96 offen offset:1536 sc1
    v_mfma_f32_16x16x32_bf16 v[218:221], a[92:95], v[154:157], v[218:221]
    v_mfma_f32_16x16x32_bf16 v[206:209], a[96:99], v[158:161], v[206:209]
    buffer_load_dwordx4 v[82:85], v9, s[76:79], 0 offen offset:2048 sc1
    v_mfma_f32_16x16x32_bf16 v[210:213], a[100:103], v[158:161], v[210:213]
    v_mfma_f32_16x16x32_bf16 v[214:217], a[104:107], v[158:161], v[214:217]
    v_mfma_f32_16x16x32_bf16 v[218:221], a[108:111], v[158:161], v[218:221]
    v_mfma_f32_16x16x32_bf16 v[206:209], a[112:115], v[162:165], v[206:209]
    buffer_load_dwordx4 v[86:89], v9, s[76:79], s84 offen offset:0 sc1
    v_mfma_f32_16x16x32_bf16 v[210:213], a[116:119], v[162:165], v[210:213]
    v_mfma_f32_16x16x32_bf16 v[214:217], a[120:123], v[162:165], v[214:217]
    v_mfma_f32_16x16x32_bf16 v[218:221], a[124:127], v[162:165], v[218:221]
    v_mfma_f32_16x16x32_bf16 v[206:209], a[128:131], v[166:169], v[206:209]
    buffer_load_dwordx4 v[90:93], v9, s[76:79], s84 offen offset:2048 sc1
    v_mfma_f32_16x16x32_bf16 v[210:213], a[132:135], v[166:169], v[210:213]
    v_mfma_f32_16x16x32_bf16 v[214:217], a[136:139], v[166:169], v[214:217]
    v_mfma_f32_16x16x32_bf16 v[218:221], a[140:143], v[166:169], v[218:221]
    v_mfma_f32_16x16x32_bf16 v[206:209], a[144:147], v[170:173], v[206:209]
    buffer_load_dwordx4 v[94:97], v9, s[76:79], s85 offen offset:0 sc1
    v_mfma_f32_16x16x32_bf16 v[210:213], a[148:151], v[170:173], v[210:213]
    v_mfma_f32_16x16x32_bf16 v[214:217], a[152:155], v[170:173], v[214:217]
    v_mfma_f32_16x16x32_bf16 v[218:221], a[156:159], v[170:173], v[218:221]
    v_mfma_f32_16x16x32_bf16 v[206:209], a[160:163], v[174:177], v[206:209]
    buffer_load_dwordx4 v[98:101], v9, s[76:79], s85 offen offset:2048 sc1
    v_mfma_f32_16x16x32_bf16 v[210:213], a[164:167], v[174:177], v[210:213]
    v_mfma_f32_16x16x32_bf16 v[214:217], a[168:171], v[174:177], v[214:217]
    v_mfma_f32_16x16x32_bf16 v[218:221], a[172:175], v[174:177], v[218:221]
    v_mfma_f32_16x16x32_bf16 v[206:209], a[176:179], v[178:181], v[206:209]
    buffer_load_dwordx4 v[102:105], v9, s[76:79], s86 offen offset:0 sc1
    v_mfma_f32_16x16x32_bf16 v[210:213], a[180:183], v[178:181], v[210:213]
    v_mfma_f32_16x16x32_bf16 v[214:217], a[184:187], v[178:181], v[214:217]
    v_mfma_f32_16x16x32_bf16 v[218:221], a[188:191], v[178:181], v[218:221]
    s_waitcnt vmcnt(6)
    v_mfma_f32_16x16x32_bf16 v[206:209], a[192:195], v[182:185], v[206:209]
    buffer_load_dwordx4 v[106:109], v9, s[76:79], s86 offen offset:2048 sc1
    v_cmp_ne_u32 vcc, s8, v5
    v_mfma_f32_16x16x32_bf16 v[210:213], a[196:199], v[182:185], v[210:213]
    s_cbranch_vccnz L43
L44:
    v_mfma_f32_16x16x32_bf16 v[214:217], a[200:203], v[182:185], v[214:217]
    v_mfma_f32_16x16x32_bf16 v[218:221], a[204:207], v[182:185], v[218:221]
    v_mfma_f32_16x16x32_bf16 v[206:209], a[208:211], v[186:189], v[206:209]
    buffer_load_dwordx4 v[110:113], v9, s[76:79], s87 offen offset:0 sc1
    v_mfma_f32_16x16x32_bf16 v[210:213], a[212:215], v[186:189], v[210:213]
    v_mfma_f32_16x16x32_bf16 v[214:217], a[216:219], v[186:189], v[214:217]
    v_mfma_f32_16x16x32_bf16 v[218:221], a[220:223], v[186:189], v[218:221]
    s_waitcnt vmcnt(7)
    v_mfma_f32_16x16x32_bf16 v[134:137], a[0:3], v[78:81], 0
    buffer_load_dwordx4 v[114:117], v9, s[76:79], s87 offen offset:2048 sc1
    v_mfma_f32_16x16x32_bf16 v[138:141], a[4:7], v[78:81], 0
    v_mfma_f32_16x16x32_bf16 v[142:145], a[8:11], v[78:81], 0
    v_mfma_f32_16x16x32_bf16 v[146:149], a[12:15], v[78:81], 0
    ds_write_b128 v15, v[190:193] offset:0
    v_mfma_f32_16x16x32_bf16 v[134:137], a[16:19], v[82:85], v[134:137]
    buffer_load_dwordx4 v[118:121], v9, s[76:79], s88 offen offset:0 sc1
    v_mfma_f32_16x16x32_bf16 v[138:141], a[20:23], v[82:85], v[138:141]
    ds_write_b128 v15, v[194:197] offset:64
    v_mfma_f32_16x16x32_bf16 v[142:145], a[24:27], v[82:85], v[142:145]
    v_mfma_f32_16x16x32_bf16 v[146:149], a[28:31], v[82:85], v[146:149]
    ds_write_b128 v15, v[198:201] offset:128
    s_waitcnt vmcnt(7)
    v_mfma_f32_16x16x32_bf16 v[134:137], a[32:35], v[86:89], v[134:137]
    buffer_load_dwordx4 v[122:125], v9, s[76:79], s88 offen offset:2048 sc1
    v_mfma_f32_16x16x32_bf16 v[138:141], a[36:39], v[86:89], v[138:141]
    ds_write_b128 v15, v[202:205] offset:192
    v_mfma_f32_16x16x32_bf16 v[142:145], a[40:43], v[86:89], v[142:145]
    v_mfma_f32_16x16x32_bf16 v[146:149], a[44:47], v[86:89], v[146:149]
    ds_write_b128 v15, v[206:209] offset:4352
    v_mfma_f32_16x16x32_bf16 v[134:137], a[48:51], v[90:93], v[134:137]
    buffer_load_dwordx4 v[126:129], v9, s[76:79], s89 offen offset:0 sc1
    v_mfma_f32_16x16x32_bf16 v[138:141], a[52:55], v[90:93], v[138:141]
    ds_write_b128 v15, v[210:213] offset:4416
    v_mfma_f32_16x16x32_bf16 v[142:145], a[56:59], v[90:93], v[142:145]
    v_mfma_f32_16x16x32_bf16 v[146:149], a[60:63], v[90:93], v[146:149]
    ds_write_b128 v15, v[214:217] offset:4480
    s_waitcnt vmcnt(7)
    v_mfma_f32_16x16x32_bf16 v[134:137], a[64:67], v[94:97], v[134:137]
    buffer_load_dwordx4 v[130:133], v9, s[76:79], s89 offen offset:2048 sc1
    v_mfma_f32_16x16x32_bf16 v[138:141], a[68:71], v[94:97], v[138:141]
    ds_write_b128 v15, v[218:221] offset:4544
    v_mfma_f32_16x16x32_bf16 v[142:145], a[72:75], v[94:97], v[142:145]
    v_mfma_f32_16x16x32_bf16 v[146:149], a[76:79], v[94:97], v[146:149]
    s_waitcnt lgkmcnt(0)
    s_barrier
    v_mfma_f32_16x16x32_bf16 v[134:137], a[80:83], v[98:101], v[134:137]
    buffer_load_dwordx4 v[22:25], v9, s[76:79], 0 offen offset:256 sc1
    ds_read_b128 v[190:193], v16 offset:0
    v_mfma_f32_16x16x32_bf16 v[138:141], a[84:87], v[98:101], v[138:141]
    ds_read_b128 v[194:197], v16 offset:16
    ds_read_b128 v[198:201], v16 offset:8704
    v_mfma_f32_16x16x32_bf16 v[142:145], a[88:91], v[98:101], v[142:145]
    ds_read_b128 v[202:205], v16 offset:8720
    ds_read_b128 v[206:209], v16 offset:17408
    v_mfma_f32_16x16x32_bf16 v[146:149], a[92:95], v[98:101], v[146:149]
    ds_read_b128 v[210:213], v16 offset:17424
    s_waitcnt vmcnt(7)
    v_mfma_f32_16x16x32_bf16 v[134:137], a[96:99], v[102:105], v[134:137]
    buffer_load_dwordx4 v[26:29], v9, s[76:79], 0 offen offset:2304 sc1
    ds_read_b128 v[214:217], v16 offset:26112
    v_mfma_f32_16x16x32_bf16 v[138:141], a[100:103], v[102:105], v[138:141]
    ds_read_b128 v[218:221], v16 offset:26128
    v_mfma_f32_16x16x32_bf16 v[142:145], a[104:107], v[102:105], v[142:145]
    v_mfma_f32_16x16x32_bf16 v[146:149], a[108:111], v[102:105], v[146:149]
    v_mfma_f32_16x16x32_bf16 v[134:137], a[112:115], v[106:109], v[134:137]
    buffer_load_dwordx4 v[30:33], v9, s[76:79], s84 offen offset:256 sc1
    v_mfma_f32_16x16x32_bf16 v[138:141], a[116:119], v[106:109], v[138:141]
    v_mfma_f32_16x16x32_bf16 v[142:145], a[120:123], v[106:109], v[142:145]
    s_waitcnt lgkmcnt(0)
    s_barrier
    v_mfma_f32_16x16x32_bf16 v[146:149], a[124:127], v[106:109], v[146:149]
    v_add_f32 v190, v190, v198
    s_waitcnt vmcnt(7)
    v_mfma_f32_16x16x32_bf16 v[134:137], a[128:131], v[110:113], v[134:137]
    buffer_load_dwordx4 v[34:37], v9, s[76:79], s84 offen offset:2304 sc1
    v_add_f32 v191, v191, v199
    v_mfma_f32_16x16x32_bf16 v[138:141], a[132:135], v[110:113], v[138:141]
    v_add_f32 v192, v192, v200
    v_add_f32 v193, v193, v201
    v_mfma_f32_16x16x32_bf16 v[142:145], a[136:139], v[110:113], v[142:145]
    v_add_f32 v194, v194, v202
    v_add_f32 v195, v195, v203
    v_mfma_f32_16x16x32_bf16 v[146:149], a[140:143], v[110:113], v[146:149]
    v_add_f32 v196, v196, v204
    v_add_f32 v197, v197, v205
    v_mfma_f32_16x16x32_bf16 v[134:137], a[144:147], v[114:117], v[134:137]
    buffer_load_dwordx4 v[38:41], v9, s[76:79], s85 offen offset:256 sc1
    v_add_f32 v206, v206, v214
    v_mfma_f32_16x16x32_bf16 v[138:141], a[148:151], v[114:117], v[138:141]
    v_add_f32 v207, v207, v215
    v_add_f32 v208, v208, v216
    v_mfma_f32_16x16x32_bf16 v[142:145], a[152:155], v[114:117], v[142:145]
    v_add_f32 v209, v209, v217
    v_add_f32 v210, v210, v218
    v_mfma_f32_16x16x32_bf16 v[146:149], a[156:159], v[114:117], v[146:149]
    v_add_f32 v211, v211, v219
    s_waitcnt vmcnt(7)
    v_mfma_f32_16x16x32_bf16 v[134:137], a[160:163], v[118:121], v[134:137]
    buffer_load_dwordx4 v[42:45], v9, s[76:79], s85 offen offset:2304 sc1
    v_add_f32 v212, v212, v220
    v_mfma_f32_16x16x32_bf16 v[138:141], a[164:167], v[118:121], v[138:141]
    v_add_f32 v213, v213, v221
    v_add_f32 v190, v190, v206
    v_mfma_f32_16x16x32_bf16 v[142:145], a[168:171], v[118:121], v[142:145]
    v_add_f32 v191, v191, v207
    v_add_f32 v192, v192, v208
    v_mfma_f32_16x16x32_bf16 v[146:149], a[172:175], v[118:121], v[146:149]
    v_add_f32 v193, v193, v209
    v_add_f32 v194, v194, v210
    v_mfma_f32_16x16x32_bf16 v[134:137], a[176:179], v[122:125], v[134:137]
    buffer_load_dwordx4 v[46:49], v9, s[76:79], s86 offen offset:256 sc1
    v_add_f32 v195, v195, v211
    v_mfma_f32_16x16x32_bf16 v[138:141], a[180:183], v[122:125], v[138:141]
    v_add_f32 v196, v196, v212
    v_add_f32 v197, v197, v213
    v_mfma_f32_16x16x32_bf16 v[142:145], a[184:187], v[122:125], v[142:145]
    v_cvt_pk_bf16_f32 v198, v190, v191
    v_cvt_pk_bf16_f32 v199, v192, v193
    v_mfma_f32_16x16x32_bf16 v[146:149], a[188:191], v[122:125], v[146:149]
    v_cvt_pk_bf16_f32 v200, v194, v195
    s_waitcnt vmcnt(7)
    v_mfma_f32_16x16x32_bf16 v[134:137], a[192:195], v[126:129], v[134:137]
    buffer_load_dwordx4 v[50:53], v9, s[76:79], s86 offen offset:2304 sc1
    v_cvt_pk_bf16_f32 v201, v196, v197
    v_mfma_f32_16x16x32_bf16 v[138:141], a[196:199], v[126:129], v[138:141]
    buffer_store_dwordx4 v[198:201], v13, s[76:79], 0 offen
    v_mfma_f32_16x16x32_bf16 v[142:145], a[200:203], v[126:129], v[142:145]
    v_mfma_f32_16x16x32_bf16 v[146:149], a[204:207], v[126:129], v[146:149]
    v_mfma_f32_16x16x32_bf16 v[134:137], a[208:211], v[130:133], v[134:137]
    buffer_load_dwordx4 v[54:57], v9, s[76:79], s87 offen offset:256 sc1
    v_mfma_f32_16x16x32_bf16 v[138:141], a[212:215], v[130:133], v[138:141]
    v_mfma_f32_16x16x32_bf16 v[142:145], a[216:219], v[130:133], v[142:145]
    v_mfma_f32_16x16x32_bf16 v[146:149], a[220:223], v[130:133], v[146:149]
    s_waitcnt vmcnt(8)
    v_mfma_f32_16x16x32_bf16 v[150:153], a[0:3], v[22:25], 0
    buffer_load_dwordx4 v[58:61], v9, s[76:79], s87 offen offset:2304 sc1
    v_mfma_f32_16x16x32_bf16 v[154:157], a[4:7], v[22:25], 0
    v_mfma_f32_16x16x32_bf16 v[158:161], a[8:11], v[22:25], 0
    v_mfma_f32_16x16x32_bf16 v[162:165], a[12:15], v[22:25], 0
    ds_write_b128 v15, v[134:137] offset:0
    v_mfma_f32_16x16x32_bf16 v[150:153], a[16:19], v[26:29], v[150:153]
    buffer_load_dwordx4 v[62:65], v9, s[76:79], s88 offen offset:256 sc1
    v_mfma_f32_16x16x32_bf16 v[154:157], a[20:23], v[26:29], v[154:157]
    ds_write_b128 v15, v[138:141] offset:64
    v_mfma_f32_16x16x32_bf16 v[158:161], a[24:27], v[26:29], v[158:161]
    v_mfma_f32_16x16x32_bf16 v[162:165], a[28:31], v[26:29], v[162:165]
    ds_write_b128 v15, v[142:145] offset:128
    s_waitcnt vmcnt(8)
    v_mfma_f32_16x16x32_bf16 v[150:153], a[32:35], v[30:33], v[150:153]
    buffer_load_dwordx4 v[66:69], v9, s[76:79], s88 offen offset:2304 sc1
    v_mfma_f32_16x16x32_bf16 v[154:157], a[36:39], v[30:33], v[154:157]
    ds_write_b128 v15, v[146:149] offset:192
    v_mfma_f32_16x16x32_bf16 v[158:161], a[40:43], v[30:33], v[158:161]
    s_waitcnt vmcnt(4)
    v_mfma_f32_16x16x32_bf16 v[162:165], a[44:47], v[30:33], v[162:165]
    s_cmp_lg_u32 s11, 0
    s_cbranch_scc1 L53
    buffer_store_dword v4, v3, s[76:79], s99 offen offset:0
L54:
    v_mfma_f32_16x16x32_bf16 v[150:153], a[48:51], v[34:37], v[150:153]
    buffer_load_dwordx4 v[70:73], v9, s[76:79], s89 offen offset:256 sc1
    v_lshlrev_b32 v102, 16, v232
    v_mfma_f32_16x16x32_bf16 v[154:157], a[52:55], v[34:37], v[154:157]
    v_and_b32 v103, 0xffff0000, v232
    v_lshlrev_b32 v104, 16, v233
    v_mfma_f32_16x16x32_bf16 v[158:161], a[56:59], v[34:37], v[158:161]
    v_and_b32 v105, 0xffff0000, v233
    v_lshlrev_b32 v106, 16, v234
    v_mfma_f32_16x16x32_bf16 v[162:165], a[60:63], v[34:37], v[162:165]
    v_and_b32 v107, 0xffff0000, v234
    v_mfma_f32_16x16x32_bf16 v[150:153], a[64:67], v[38:41], v[150:153]
    buffer_load_dwordx4 v[74:77], v9, s[76:79], s89 offen offset:2304 sc1
    v_lshlrev_b32 v108, 16, v235
    v_mfma_f32_16x16x32_bf16 v[154:157], a[68:71], v[38:41], v[154:157]
    v_and_b32 v109, 0xffff0000, v235
    v_bfe_u32 v131, v2, 4, 2
    v_mfma_f32_16x16x32_bf16 v[158:161], a[72:75], v[38:41], v[158:161]
    v_mul_u32_u24 v131, 1088, v131
    v_lshrrev_b32 v130, 6, v2
    v_mfma_f32_16x16x32_bf16 v[162:165], a[76:79], v[38:41], v[162:165]
    v_lshl_add_u32 v131, v130, 4, v131
    v_add_u32 v131, s57, v131
    v_mfma_f32_16x16x32_bf16 v[150:153], a[80:83], v[42:45], v[150:153]
    v_add_u32 v130, s56, v2
    v_mfma_f32_16x16x32_bf16 v[154:157], a[84:87], v[42:45], v[154:157]
    v_mfma_f32_16x16x32_bf16 v[158:161], a[88:91], v[42:45], v[158:161]
    v_mfma_f32_16x16x32_bf16 v[162:165], a[92:95], v[42:45], v[162:165]
    v_mfma_f32_16x16x32_bf16 v[150:153], a[96:99], v[46:49], v[150:153]
    v_mfma_f32_16x16x32_bf16 v[154:157], a[100:103], v[46:49], v[154:157]
    v_mfma_f32_16x16x32_bf16 v[158:161], a[104:107], v[46:49], v[158:161]
    v_mfma_f32_16x16x32_bf16 v[162:165], a[108:111], v[46:49], v[162:165]
    v_mfma_f32_16x16x32_bf16 v[150:153], a[112:115], v[50:53], v[150:153]
    v_mfma_f32_16x16x32_bf16 v[154:157], a[116:119], v[50:53], v[154:157]
    v_mfma_f32_16x16x32_bf16 v[158:161], a[120:123], v[50:53], v[158:161]
    buffer_load_dword v5, v18, s[76:79], s98 offen offset:0 sc1
    v_mfma_f32_16x16x32_bf16 v[162:165], a[124:127], v[50:53], v[162:165]
    s_waitcnt vmcnt(6)
    v_mfma_f32_16x16x32_bf16 v[150:153], a[128:131], v[54:57], v[150:153]
    v_mfma_f32_16x16x32_bf16 v[154:157], a[132:135], v[54:57], v[154:157]
    v_mfma_f32_16x16x32_bf16 v[158:161], a[136:139], v[54:57], v[158:161]
    v_mfma_f32_16x16x32_bf16 v[162:165], a[140:143], v[54:57], v[162:165]
    v_mfma_f32_16x16x32_bf16 v[150:153], a[144:147], v[58:61], v[150:153]
    v_mfma_f32_16x16x32_bf16 v[154:157], a[148:151], v[58:61], v[154:157]
    v_mfma_f32_16x16x32_bf16 v[158:161], a[152:155], v[58:61], v[158:161]
    v_mfma_f32_16x16x32_bf16 v[162:165], a[156:159], v[58:61], v[162:165]
    s_waitcnt vmcnt(4)
    v_mfma_f32_16x16x32_bf16 v[150:153], a[160:163], v[62:65], v[150:153]
    v_mfma_f32_16x16x32_bf16 v[154:157], a[164:167], v[62:65], v[154:157]
    v_mfma_f32_16x16x32_bf16 v[158:161], a[168:171], v[62:65], v[158:161]
    v_mfma_f32_16x16x32_bf16 v[162:165], a[172:175], v[62:65], v[162:165]
    v_mfma_f32_16x16x32_bf16 v[150:153], a[176:179], v[66:69], v[150:153]
    v_mfma_f32_16x16x32_bf16 v[154:157], a[180:183], v[66:69], v[154:157]
    v_mfma_f32_16x16x32_bf16 v[158:161], a[184:187], v[66:69], v[158:161]
    v_mfma_f32_16x16x32_bf16 v[162:165], a[188:191], v[66:69], v[162:165]
    s_waitcnt vmcnt(1)
    v_mfma_f32_16x16x32_bf16 v[150:153], a[192:195], v[70:73], v[150:153]
    s_waitcnt vmcnt(0)
    v_cmp_ne_u32 vcc, s8, v5
    v_mfma_f32_16x16x32_bf16 v[154:157], a[196:199], v[70:73], v[154:157]
    s_cbranch_vccnz L50
L51:
    buffer_load_dwordx4 v[78:81], v0, s[76:79], s100 offen sc1
    v_mfma_f32_16x16x32_bf16 v[158:161], a[200:203], v[70:73], v[158:161]
    v_mfma_f32_16x16x32_bf16 v[162:165], a[204:207], v[70:73], v[162:165]
    v_mfma_f32_16x16x32_bf16 v[150:153], a[208:211], v[74:77], v[150:153]
    v_mfma_f32_16x16x32_bf16 v[154:157], a[212:215], v[74:77], v[154:157]
    v_mfma_f32_16x16x32_bf16 v[158:161], a[216:219], v[74:77], v[158:161]
    v_mfma_f32_16x16x32_bf16 v[162:165], a[220:223], v[74:77], v[162:165]
    s_nop 4
    ds_write_b128 v15, v[150:153] offset:4352
    ds_write_b128 v15, v[154:157] offset:4416
    ds_write_b128 v15, v[158:161] offset:4480
    ds_write_b128 v15, v[162:165] offset:4544
    s_waitcnt vmcnt(0)
    v_lshlrev_b32 v86, 16, v78
    v_and_b32 v87, 0xffff0000, v78
    v_lshlrev_b32 v88, 16, v79
    v_and_b32 v89, 0xffff0000, v79
    v_lshlrev_b32 v90, 16, v80
    v_and_b32 v91, 0xffff0000, v80
    v_lshlrev_b32 v92, 16, v81
    v_and_b32 v93, 0xffff0000, v81
    v_pk_add_f32 v[240:241], v[240:241], v[86:87]
    v_pk_add_f32 v[242:243], v[242:243], v[88:89]
    v_pk_add_f32 v[244:245], v[244:245], v[90:91]
    v_pk_add_f32 v[246:247], v[246:247], v[92:93]
    v_pk_add_f32 v[94:95], v[240:241], v[242:243]
    v_pk_mul_f32 v[96:97], v[240:241], v[240:241]
    v_pk_add_f32 v[98:99], v[244:245], v[246:247]
    v_pk_fma_f32 v[96:97], v[242:243], v[242:243], v[96:97]
    v_pk_fma_f32 v[96:97], v[244:245], v[244:245], v[96:97]
    v_pk_fma_f32 v[96:97], v[246:247], v[246:247], v[96:97]
    v_pk_add_f32 v[94:95], v[94:95], v[98:99]
    v_add_f32 v96, v96, v97
    v_add_f32 v94, v94, v95
    s_nop 0
    v_add_f32_dpp v96, v96, v96 row_ror:8 row_mask:0xf bank_mask:0xf
    v_add_f32_dpp v94, v94, v94 row_ror:8 row_mask:0xf bank_mask:0xf
    s_nop 0
    v_add_f32_dpp v96, v96, v96 row_ror:4 row_mask:0xf bank_mask:0xf
    v_add_f32_dpp v94, v94, v94 row_ror:4 row_mask:0xf bank_mask:0xf
    s_nop 0
    v_add_f32_dpp v96, v96, v96 row_ror:2 row_mask:0xf bank_mask:0xf
    v_add_f32_dpp v94, v94, v94 row_ror:2 row_mask:0xf bank_mask:0xf
    s_nop 0
    v_add_f32_dpp v96, v96, v96 row_ror:1 row_mask:0xf bank_mask:0xf
    v_add_f32_dpp v94, v94, v94 row_ror:1 row_mask:0xf bank_mask:0xf
    s_nop 0
    v_add_f32_dpp v96, v96, v96 row_bcast:15 row_mask:0xa bank_mask:0xf
    v_add_f32_dpp v94, v94, v94 row_bcast:15 row_mask:0xa bank_mask:0xf
    s_nop 0
    v_add_f32_dpp v96, v96, v96 row_bcast:31 row_mask:0xc bank_mask:0xf
    v_add_f32_dpp v94, v94, v94 row_bcast:31 row_mask:0xc bank_mask:0xf
    v_mul_f32 v94, 0x3b000000, v94
    v_mul_f32 v96, 0x3b000000, v96
    v_fma_f32 v96, -v94, v94, v96
    v_max_f32 v96, 0, v96
    v_add_f32 v96, 0x3727c5ac, v96
    v_rsq_f32 v96, v96
    s_nop 0
    v_mul_f32_e64 v94, -v94, v96
    v_readlane_b32 s36, v96, 63
    v_readlane_b32 s38, v94, 63
    s_nop 1
    v_mov_b32 v98, s38
    v_pk_fma_f32 v[86:87], v[240:241], s[36:37], v[98:99] op_sel_hi:[1,0,0]
    v_pk_fma_f32 v[88:89], v[242:243], s[36:37], v[98:99] op_sel_hi:[1,0,0]
    v_pk_fma_f32 v[90:91], v[244:245], s[36:37], v[98:99] op_sel_hi:[1,0,0]
    v_pk_fma_f32 v[92:93], v[246:247], s[36:37], v[98:99] op_sel_hi:[1,0,0]
    v_pk_fma_f32 v[240:241], v[86:87], v[102:103], v[240:241]
    v_pk_fma_f32 v[242:243], v[88:89], v[104:105], v[242:243]
    v_pk_fma_f32 v[244:245], v[90:91], v[106:107], v[244:245]
    v_pk_fma_f32 v[246:247], v[92:93], v[108:109], v[246:247]
    v_pk_add_f32 v[118:119], v[240:241], v[242:243]
    v_pk_mul_f32 v[120:121], v[240:241], v[240:241]
    v_pk_add_f32 v[122:123], v[244:245], v[246:247]
    v_pk_fma_f32 v[120:121], v[242:243], v[242:243], v[120:121]
    v_pk_fma_f32 v[120:121], v[244:245], v[244:245], v[120:121]
    v_pk_fma_f32 v[120:121], v[246:247], v[246:247], v[120:121]
    v_pk_add_f32 v[118:119], v[118:119], v[122:123]
    v_add_f32 v120, v120, v121
    v_add_f32 v118, v118, v119
    s_nop 0
    v_add_f32_dpp v120, v120, v120 row_ror:8 row_mask:0xf bank_mask:0xf
    v_add_f32_dpp v118, v118, v118 row_ror:8 row_mask:0xf bank_mask:0xf
    s_nop 0
    v_add_f32_dpp v120, v120, v120 row_ror:4 row_mask:0xf bank_mask:0xf
    v_add_f32_dpp v118, v118, v118 row_ror:4 row_mask:0xf bank_mask:0xf
    s_nop 0
    v_add_f32_dpp v120, v120, v120 row_ror:2 row_mask:0xf bank_mask:0xf
    v_add_f32_dpp v118, v118, v118 row_ror:2 row_mask:0xf bank_mask:0xf
    s_nop 0
    v_add_f32_dpp v120, v120, v120 row_ror:1 row_mask:0xf bank_mask:0xf
    v_add_f32_dpp v118, v118, v118 row_ror:1 row_mask:0xf bank_mask:0xf
    s_nop 0
    v_add_f32_dpp v120, v120, v120 row_bcast:15 row_mask:0xa bank_mask:0xf
    v_add_f32_dpp v118, v118, v118 row_bcast:15 row_mask:0xa bank_mask:0xf
    s_nop 0
    v_add_f32_dpp v120, v120, v120 row_bcast:31 row_mask:0xc bank_mask:0xf
    v_add_f32_dpp v118, v118, v118 row_bcast:31 row_mask:0xc bank_mask:0xf
    v_mul_f32 v118, 0x3b000000, v118
    v_mul_f32 v120, 0x3b000000, v120
    v_fma_f32 v120, -v118, v118, v120
    v_max_f32 v120, 0, v120
    v_add_f32 v120, 0x3727c5ac, v120
    v_rsq_f32 v120, v120
    s_nop 0
    v_mul_f32 v120, 0x3fb8aa3b, v120
    v_mul_f32_e64 v118, -v118, v120
    v_readlane_b32 s36, v120, 63
    v_readlane_b32 s38, v118, 63
    s_nop 1
    v_mov_b32 v122, s38
    v_pk_fma_f32 v[102:103], v[240:241], s[36:37], v[122:123] op_sel_hi:[1,0,0]
    v_pk_fma_f32 v[104:105], v[242:243], s[36:37], v[122:123] op_sel_hi:[1,0,0]
    v_pk_fma_f32 v[106:107], v[244:245], s[36:37], v[122:123] op_sel_hi:[1,0,0]
    v_pk_fma_f32 v[108:109], v[246:247], s[36:37], v[122:123] op_sel_hi:[1,0,0]
    v_cvt_pk_bf16_f32 v110, v102, v103
    v_cvt_pk_bf16_f32 v111, v104, v105
    v_cvt_pk_bf16_f32 v112, v106, v107
    v_cvt_pk_bf16_f32 v113, v108, v109
    ds_write_b128 v130, v[110:113] offset:44800
    v_cvt_pk_bf16_f32 v114, v240, v241
    v_cvt_pk_bf16_f32 v115, v242, v243
    v_cvt_pk_bf16_f32 v116, v244, v245
    v_cvt_pk_bf16_f32 v117, v246, v247
    buffer_store_dwordx4 v[114:117], v0, s[76:79], s100 offen
    s_waitcnt lgkmcnt(0)
    s_barrier
    ds_read_b128 v[78:81], v131 offset:44800
    s_waitcnt lgkmcnt(0)
    buffer_store_dwordx4 v[78:81], v12, s[76:79], 0 offen
    ds_read_b128 v[22:25], v16 offset:0
    ds_read_b128 v[26:29], v16 offset:16
    ds_read_b128 v[30:33], v16 offset:8704
    ds_read_b128 v[34:37], v16 offset:8720
    ds_read_b128 v[38:41], v16 offset:17408
    ds_read_b128 v[42:45], v16 offset:17424
    ds_read_b128 v[46:49], v16 offset:26112
    ds_read_b128 v[50:53], v16 offset:26128
    s_waitcnt vmcnt(0)
    s_cmp_lg_u32 s11, 0
    s_cbranch_scc1 L55
    buffer_store_dword v4, v3, s[76:79], s95 offen offset:1024
L56:
    s_waitcnt lgkmcnt(0)
    buffer_load_dword v5, v17, s[76:79], s94 offen offset:1024 sc1
    v_pk_add_f32 v[22:23], v[22:23], v[30:31]
    v_pk_add_f32 v[24:25], v[24:25], v[32:33]
    v_pk_add_f32 v[26:27], v[26:27], v[34:35]
    v_pk_add_f32 v[28:29], v[28:29], v[36:37]
    v_pk_add_f32 v[38:39], v[38:39], v[46:47]
    v_pk_add_f32 v[40:41], v[40:41], v[48:49]
    v_pk_add_f32 v[42:43], v[42:43], v[50:51]
    v_pk_add_f32 v[44:45], v[44:45], v[52:53]
    v_pk_add_f32 v[22:23], v[22:23], v[38:39]
    v_pk_add_f32 v[24:25], v[24:25], v[40:41]
    v_pk_add_f32 v[26:27], v[26:27], v[42:43]
    v_pk_add_f32 v[28:29], v[28:29], v[44:45]
    v_cvt_pk_bf16_f32 v30, v22, v23
    v_cvt_pk_bf16_f32 v31, v24, v25
    v_cvt_pk_bf16_f32 v32, v26, v27
    v_cvt_pk_bf16_f32 v33, v28, v29
    buffer_store_dwordx4 v[30:33], v13, s[76:79], s84 offen
    ds_read_b128 v[134:137], v2 offset:0
    ds_read_b128 v[138:141], v2 offset:1024
    ds_read_b128 v[142:145], v2 offset:2048
    ds_read_b128 v[146:149], v2 offset:3072
    ds_read_b128 v[150:153], v2 offset:4096
    ds_read_b128 v[154:157], v2 offset:5120
    ds_read_b128 v[158:161], v2 offset:6144
    s_waitcnt vmcnt(1)
    v_cmp_ne_u32 vcc, s8, v5
    s_cbranch_vccnz L57
L58:
    buffer_load_dwordx4 v[190:193], v6, s[76:79], 0 offen offset:0 sc1
    buffer_load_dwordx4 v[194:197], v6, s[76:79], 0 offen offset:1024 sc1
    buffer_load_dwordx4 v[198:201], v6, s[76:79], 0 offen offset:2048 sc1
    buffer_load_dwordx4 v[202:205], v6, s[76:79], 0 offen offset:3072 sc1
    buffer_load_dwordx4 v[206:209], v6, s[76:79], s84 offen offset:0 sc1
    buffer_load_dwordx4 v[210:213], v6, s[76:79], s84 offen offset:1024 sc1
    buffer_load_dwordx4 v[214:217], v6, s[76:79], s84 offen offset:2048 sc1
    buffer_load_dwordx4 v[218:221], v6, s[76:79], s84 offen offset:3072 sc1
    buffer_load_dwordx4 a[224:227], v6, s[76:79], s85 offen offset:0 sc1
    buffer_load_dwordx4 a[228:231], v6, s[76:79], s85 offen offset:1024 sc1
    s_waitcnt vmcnt(8) lgkmcnt(0)
    v_mfma_f32_16x16x32_bf16 v[22:25], v[134:137], v[190:193], 0
    ds_read_b128 v[162:165], v2 offset:7168
    ds_read_b128 v[166:169], v2 offset:8192
    v_mfma_f32_16x16x32_bf16 v[50:53], v[134:137], v[194:197], 0
    v_mfma_f32_16x16x32_bf16 v[26:29], v[138:141], v[190:193], 0
    ds_read_b128 v[170:173], v2 offset:9216
    ds_read_b128 v[174:177], v2 offset:10240
    v_mfma_f32_16x16x32_bf16 v[54:57], v[138:141], v[194:197], 0
    v_mfma_f32_16x16x32_bf16 v[30:33], v[142:145], v[190:193], 0
    ds_read_b128 v[178:181], v2 offset:11264
    ds_read_b128 v[182:185], v2 offset:12288
    v_mfma_f32_16x16x32_bf16 v[58:61], v[142:145], v[194:197], 0
    v_mfma_f32_16x16x32_bf16 v[34:37], v[146:149], v[190:193], 0
    ds_read_b128 v[186:189], v2 offset:13312
    buffer_load_dwordx4 a[232:235], v6, s[76:79], s85 offen offset:2048 sc1
    v_mfma_f32_16x16x32_bf16 v[62:65], v[146:149], v[194:197], 0
    s_cmp_lg_u32 s11, 0
    s_cbranch_scc1 L63
    buffer_store_dword v4, v3, s[76:79], s99 offen offset:512
L64:
    v_mfma_f32_16x16x32_bf16 v[38:41], v[150:153], v[190:193], 0
    buffer_load_dwordx4 a[236:239], v6, s[76:79], s85 offen offset:3072 sc1
    v_mfma_f32_16x16x32_bf16 v[66:69], v[150:153], v[194:197], 0
    v_mfma_f32_16x16x32_bf16 v[42:45], v[154:157], v[190:193], 0
    v_mfma_f32_16x16x32_bf16 v[70:73], v[154:157], v[194:197], 0
    v_mfma_f32_16x16x32_bf16 v[46:49], v[158:161], v[190:193], 0
    v_mfma_f32_16x16x32_bf16 v[74:77], v[158:161], v[194:197], 0
    s_waitcnt vmcnt(9) lgkmcnt(0)
    v_mfma_f32_16x16x32_bf16 v[22:25], v[162:165], v[198:201], v[22:25]
    ds_read_b128 v[134:137], v2 offset:14336
    ds_read_b128 v[138:141], v2 offset:15360
    v_mfma_f32_16x16x32_bf16 v[50:53], v[162:165], v[202:205], v[50:53]
    v_mfma_f32_16x16x32_bf16 v[26:29], v[166:169], v[198:201], v[26:29]
    ds_read_b128 v[142:145], v2 offset:16384
    ds_read_b128 v[146:149], v2 offset:17408
    v_mfma_f32_16x16x32_bf16 v[54:57], v[166:169], v[202:205], v[54:57]
    v_mfma_f32_16x16x32_bf16 v[30:33], v[170:173], v[198:201], v[30:33]
    ds_read_b128 v[150:153], v2 offset:18432
    ds_read_b128 v[154:157], v2 offset:19456
    v_mfma_f32_16x16x32_bf16 v[58:61], v[170:173], v[202:205], v[58:61]
    v_mfma_f32_16x16x32_bf16 v[34:37], v[174:177], v[198:201], v[34:37]
    ds_read_b128 v[158:161], v2 offset:20480
    buffer_load_dwordx4 v[190:193], v6, s[76:79], s86 offen offset:0 sc1
    v_mfma_f32_16x16x32_bf16 v[62:65], v[174:177], v[202:205], v[62:65]
    v_mfma_f32_16x16x32_bf16 v[38:41], v[178:181], v[198:201], v[38:41]
    buffer_load_dwordx4 v[194:197], v6, s[76:79], s86 offen offset:1024 sc1
    v_mfma_f32_16x16x32_bf16 v[66:69], v[178:181], v[202:205], v[66:69]
    v_mfma_f32_16x16x32_bf16 v[42:45], v[182:185], v[198:201], v[42:45]
    v_mfma_f32_16x16x32_bf16 v[70:73], v[182:185], v[202:205], v[70:73]
    v_mfma_f32_16x16x32_bf16 v[46:49], v[186:189], v[198:201], v[46:49]
    v_mfma_f32_16x16x32_bf16 v[74:77], v[186:189], v[202:205], v[74:77]
    s_waitcnt vmcnt(9) lgkmcnt(0)
    v_mfma_f32_16x16x32_bf16 v[22:25], v[134:137], v[206:209], v[22:25]
    ds_read_b128 v[162:165], v2 offset:21504
    ds_read_b128 v[166:169], v2 offset:22528
    v_mfma_f32_16x16x32_bf16 v[50:53], v[134:137], v[210:213], v[50:53]
    v_mfma_f32_16x16x32_bf16 v[26:29], v[138:141], v[206:209], v[26:29]
    ds_read_b128 v[170:173], v2 offset:23552
    ds_read_b128 v[174:177], v2 offset:24576
    v_mfma_f32_16x16x32_bf16 v[54:57], v[138:141], v[210:213], v[54:57]
    v_mfma_f32_16x16x32_bf16 v[30:33], v[142:145], v[206:209], v[30:33]
    ds_read_b128 v[178:181], v2 offset:25600
    ds_read_b128 v[182:185], v2 offset:26624
    v_mfma_f32_16x16x32_bf16 v[58:61], v[142:145], v[210:213], v[58:61]
    v_mfma_f32_16x16x32_bf16 v[34:37], v[146:149], v[206:209], v[34:37]
    ds_read_b128 v[186:189], v2 offset:27648
    buffer_load_dwordx4 v[198:201], v6, s[76:79], s86 offen offset:2048 sc1
    v_mfma_f32_16x16x32_bf16 v[62:65], v[146:149], v[210:213], v[62:65]
    v_mfma_f32_16x16x32_bf16 v[38:41], v[150:153], v[206:209], v[38:41]
    buffer_load_dwordx4 v[202:205], v6, s[76:79], s86 offen offset:3072 sc1
    v_mfma_f32_16x16x32_bf16 v[66:69], v[150:153], v[210:213], v[66:69]
    v_mfma_f32_16x16x32_bf16 v[42:45], v[154:157], v[206:209], v[42:45]
    v_mfma_f32_16x16x32_bf16 v[70:73], v[154:157], v[210:213], v[70:73]
    v_mfma_f32_16x16x32_bf16 v[46:49], v[158:161], v[206:209], v[46:49]
    v_mfma_f32_16x16x32_bf16 v[74:77], v[158:161], v[210:213], v[74:77]
    s_waitcnt vmcnt(9) lgkmcnt(0)
    v_mfma_f32_16x16x32_bf16 v[22:25], v[162:165], v[214:217], v[22:25]
    ds_read_b128 v[134:137], v2 offset:28672
    ds_read_b128 v[138:141], v2 offset:29696
    v_mfma_f32_16x16x32_bf16 v[50:53], v[162:165], v[218:221], v[50:53]
    v_mfma_f32_16x16x32_bf16 v[26:29], v[166:169], v[214:217], v[26:29]
    ds_read_b128 v[142:145], v2 offset:30720
    ds_read_b128 v[146:149], v2 offset:31744
    v_mfma_f32_16x16x32_bf16 v[54:57], v[166:169], v[218:221], v[54:57]
    buffer_load_dword v5, v18, s[76:79], s98 offen offset:512 sc1
    v_mfma_f32_16x16x32_bf16 v[30:33], v[170:173], v[214:217], v[30:33]
    ds_read_b128 v[150:153], v2 offset:32768
    ds_read_b128 v[154:157], v2 offset:33792
    v_mfma_f32_16x16x32_bf16 v[58:61], v[170:173], v[218:221], v[58:61]
    v_mfma_f32_16x16x32_bf16 v[34:37], v[174:177], v[214:217], v[34:37]
    ds_read_b128 v[158:161], v2 offset:34816
    buffer_load_dwordx4 v[206:209], v6, s[76:79], s87 offen offset:0 sc1
    v_mfma_f32_16x16x32_bf16 v[62:65], v[174:177], v[218:221], v[62:65]
    v_mfma_f32_16x16x32_bf16 v[38:41], v[178:181], v[214:217], v[38:41]
    buffer_load_dwordx4 v[210:213], v6, s[76:79], s87 offen offset:1024 sc1
    v_mfma_f32_16x16x32_bf16 v[66:69], v[178:181], v[218:221], v[66:69]
    v_mfma_f32_16x16x32_bf16 v[42:45], v[182:185], v[214:217], v[42:45]
    v_mfma_f32_16x16x32_bf16 v[70:73], v[182:185], v[218:221], v[70:73]
    v_mfma_f32_16x16x32_bf16 v[46:49], v[186:189], v[214:217], v[46:49]
    v_mfma_f32_16x16x32_bf16 v[74:77], v[186:189], v[218:221], v[74:77]
    s_waitcnt vmcnt(10) lgkmcnt(0)
    v_mfma_f32_16x16x32_bf16 v[22:25], v[134:137], a[224:227], v[22:25]
    ds_read_b128 v[162:165], v2 offset:35840
    ds_read_b128 v[166:169], v2 offset:36864
    v_mfma_f32_16x16x32_bf16 v[50:53], v[134:137], a[228:231], v[50:53]
    v_mfma_f32_16x16x32_bf16 v[26:29], v[138:141], a[224:227], v[26:29]
    ds_read_b128 v[170:173], v2 offset:37888
    ds_read_b128 v[174:177], v2 offset:38912
    v_mfma_f32_16x16x32_bf16 v[54:57], v[138:141], a[228:231], v[54:57]
    v_mfma_f32_16x16x32_bf16 v[30:33], v[142:145], a[224:227], v[30:33]
    ds_read_b128 v[178:181], v2 offset:39936
    ds_read_b128 v[182:185], v2 offset:40960
    v_mfma_f32_16x16x32_bf16 v[58:61], v[142:145], a[228:231], v[58:61]
    v_mfma_f32_16x16x32_bf16 v[34:37], v[146:149], a[224:227], v[34:37]
    ds_read_b128 v[186:189], v2 offset:41984
    buffer_load_dwordx4 v[214:217], v6, s[76:79], s87 offen offset:2048 sc1
    v_mfma_f32_16x16x32_bf16 v[62:65], v[146:149], a[228:231], v[62:65]
    v_mfma_f32_16x16x32_bf16 v[38:41], v[150:153], a[224:227], v[38:41]
    buffer_load_dwordx4 v[218:221], v6, s[76:79], s87 offen offset:3072 sc1
    v_mfma_f32_16x16x32_bf16 v[66:69], v[150:153], a[228:231], v[66:69]
    v_mfma_f32_16x16x32_bf16 v[42:45], v[154:157], a[224:227], v[42:45]
    s_waitcnt vmcnt(4)
    v_cmp_ne_u32 vcc, s8, v5
    v_mfma_f32_16x16x32_bf16 v[70:73], v[154:157], a[228:231], v[70:73]
    s_cbranch_vccnz L60
L61:
    buffer_load_dwordx4 v[78:81], v0, s[76:79], s101 offen sc1
    v_mfma_f32_16x16x32_bf16 v[46:49], v[158:161], a[224:227], v[46:49]
    v_mfma_f32_16x16x32_bf16 v[74:77], v[158:161], a[228:231], v[74:77]
    s_waitcnt lgkmcnt(0)
    v_mfma_f32_16x16x32_bf16 v[22:25], v[162:165], a[232:235], v[22:25]
    ds_read_b128 v[134:137], v2 offset:43008
    ds_read_b128 v[138:141], v2 offset:44032
    v_mfma_f32_16x16x32_bf16 v[50:53], v[162:165], a[236:239], v[50:53]
    v_mfma_f32_16x16x32_bf16 v[26:29], v[166:169], a[232:235], v[26:29]
    ds_read_b128 v[142:145], v2 offset:45056
    ds_read_b128 v[146:149], v2 offset:46080
    v_mfma_f32_16x16x32_bf16 v[54:57], v[166:169], a[236:239], v[54:57]
    v_mfma_f32_16x16x32_bf16 v[30:33], v[170:173], a[232:235], v[30:33]
    ds_read_b128 v[150:153], v2 offset:47104
    ds_read_b128 v[154:157], v2 offset:48128
    v_mfma_f32_16x16x32_bf16 v[58:61], v[170:173], a[236:239], v[58:61]
    v_mfma_f32_16x16x32_bf16 v[34:37], v[174:177], a[232:235], v[34:37]
    ds_read_b128 v[158:161], v2 offset:49152
    buffer_load_dwordx4 a[224:227], v6, s[76:79], s88 offen offset:0 sc1
    v_mfma_f32_16x16x32_bf16 v[62:65], v[174:177], a[236:239], v[62:65]
    v_mfma_f32_16x16x32_bf16 v[38:41], v[178:181], a[232:235], v[38:41]
    buffer_load_dwordx4 a[228:231], v6, s[76:79], s88 offen offset:1024 sc1
    v_mfma_f32_16x16x32_bf16 v[66:69], v[178:181], a[236:239], v[66:69]
    v_mfma_f32_16x16x32_bf16 v[42:45], v[182:185], a[232:235], v[42:45]
    v_mfma_f32_16x16x32_bf16 v[70:73], v[182:185], a[236:239], v[70:73]
    v_mfma_f32_16x16x32_bf16 v[46:49], v[186:189], a[232:235], v[46:49]
    v_mfma_f32_16x16x32_bf16 v[74:77], v[186:189], a[236:239], v[74:77]
    s_waitcnt lgkmcnt(0)
    v_mfma_f32_16x16x32_bf16 v[22:25], v[134:137], v[190:193], v[22:25]
    ds_read_b128 v[162:165], v2 offset:50176
    ds_read_b128 v[166:169], v2 offset:51200
    v_mfma_f32_16x16x32_bf16 v[50:53], v[134:137], v[194:197], v[50:53]
    v_mfma_f32_16x16x32_bf16 v[26:29], v[138:141], v[190:193], v[26:29]
    ds_read_b128 v[170:173], v2 offset:52224
    ds_read_b128 v[174:177], v2 offset:53248
    v_mfma_f32_16x16x32_bf16 v[54:57], v[138:141], v[194:197], v[54:57]
    v_mfma_f32_16x16x32_bf16 v[30:33], v[142:145], v[190:193], v[30:33]
    ds_read_b128 v[178:181], v2 offset:54272
    ds_read_b128 v[182:185], v2 offset:55296
    v_mfma_f32_16x16x32_bf16 v[58:61], v[142:145], v[194:197], v[58:61]
    v_mfma_f32_16x16x32_bf16 v[34:37], v[146:149], v[190:193], v[34:37]
    ds_read_b128 v[186:189], v2 offset:56320
    buffer_load_dwordx4 a[232:235], v6, s[76:79], s88 offen offset:2048 sc1
    v_mfma_f32_16x16x32_bf16 v[62:65], v[146:149], v[194:197], v[62:65]
    v_mfma_f32_16x16x32_bf16 v[38:41], v[150:153], v[190:193], v[38:41]
    buffer_load_dwordx4 a[236:239], v6, s[76:79], s88 offen offset:3072 sc1
    v_mfma_f32_16x16x32_bf16 v[66:69], v[150:153], v[194:197], v[66:69]
    v_mfma_f32_16x16x32_bf16 v[42:45], v[154:157], v[190:193], v[42:45]
    v_mfma_f32_16x16x32_bf16 v[70:73], v[154:157], v[194:197], v[70:73]
    v_mfma_f32_16x16x32_bf16 v[46:49], v[158:161], v[190:193], v[46:49]
    v_mfma_f32_16x16x32_bf16 v[74:77], v[158:161], v[194:197], v[74:77]
    s_waitcnt vmcnt(4)
    v_lshlrev_b32 v86, 16, v78
    v_and_b32 v87, 0xffff0000, v78
    v_lshlrev_b32 v88, 16, v79
    v_and_b32 v89, 0xffff0000, v79
    v_lshlrev_b32 v90, 16, v80
    v_and_b32 v91, 0xffff0000, v80
    v_lshlrev_b32 v92, 16, v81
    v_and_b32 v93, 0xffff0000, v81
    v_pk_add_f32 v[248:249], v[248:249], v[86:87]
    v_pk_add_f32 v[250:251], v[250:251], v[88:89]
    v_pk_add_f32 v[252:253], v[252:253], v[90:91]
    v_pk_add_f32 v[254:255], v[254:255], v[92:93]
    v_pk_add_f32 v[94:95], v[248:249], v[250:251]
    v_pk_mul_f32 v[96:97], v[248:249], v[248:249]
    v_pk_add_f32 v[98:99], v[252:253], v[254:255]
    v_pk_fma_f32 v[96:97], v[250:251], v[250:251], v[96:97]
    v_pk_fma_f32 v[96:97], v[252:253], v[252:253], v[96:97]
    v_pk_fma_f32 v[96:97], v[254:255], v[254:255], v[96:97]
    v_pk_add_f32 v[94:95], v[94:95], v[98:99]
    v_add_f32 v96, v96, v97
    v_add_f32 v94, v94, v95
    s_nop 0
    v_add_f32_dpp v96, v96, v96 row_ror:8 row_mask:0xf bank_mask:0xf
    v_add_f32_dpp v94, v94, v94 row_ror:8 row_mask:0xf bank_mask:0xf
    s_nop 0
    v_add_f32_dpp v96, v96, v96 row_ror:4 row_mask:0xf bank_mask:0xf
    v_add_f32_dpp v94, v94, v94 row_ror:4 row_mask:0xf bank_mask:0xf
    s_nop 0
    v_add_f32_dpp v96, v96, v96 row_ror:2 row_mask:0xf bank_mask:0xf
    v_add_f32_dpp v94, v94, v94 row_ror:2 row_mask:0xf bank_mask:0xf
    s_nop 0
    v_add_f32_dpp v96, v96, v96 row_ror:1 row_mask:0xf bank_mask:0xf
    v_add_f32_dpp v94, v94, v94 row_ror:1 row_mask:0xf bank_mask:0xf
    s_nop 0
    v_add_f32_dpp v96, v96, v96 row_bcast:15 row_mask:0xa bank_mask:0xf
    v_add_f32_dpp v94, v94, v94 row_bcast:15 row_mask:0xa bank_mask:0xf
    s_nop 0
    v_add_f32_dpp v96, v96, v96 row_bcast:31 row_mask:0xc bank_mask:0xf
    v_add_f32_dpp v94, v94, v94 row_bcast:31 row_mask:0xc bank_mask:0xf
    v_mul_f32 v94, 0x3b000000, v94
    v_mul_f32 v96, 0x3b000000, v96
    v_fma_f32 v96, -v94, v94, v96
    v_max_f32 v96, 0, v96
    v_add_f32 v96, 0x3727c5ac, v96
    v_rsq_f32 v96, v96
    v_lshlrev_b32 v102, 16, v236
    v_mul_f32_e64 v94, -v94, v96
    v_readlane_b32 s36, v96, 63
    v_readlane_b32 s38, v94, 63
    v_and_b32 v103, 0xffff0000, v236
    v_lshlrev_b32 v104, 16, v237
    v_mov_b32 v98, s38
    v_pk_fma_f32 v[86:87], v[248:249], s[36:37], v[98:99] op_sel_hi:[1,0,0]
    v_pk_fma_f32 v[88:89], v[250:251], s[36:37], v[98:99] op_sel_hi:[1,0,0]
    v_pk_fma_f32 v[90:91], v[252:253], s[36:37], v[98:99] op_sel_hi:[1,0,0]
    v_pk_fma_f32 v[92:93], v[254:255], s[36:37], v[98:99] op_sel_hi:[1,0,0]
    v_and_b32 v105, 0xffff0000, v237
    v_lshlrev_b32 v106, 16, v238
    v_and_b32 v107, 0xffff0000, v238
    v_lshlrev_b32 v108, 16, v239
    v_and_b32 v109, 0xffff0000, v239
    v_pk_fma_f32 v[248:249], v[86:87], v[102:103], v[248:249]
    v_pk_fma_f32 v[250:251], v[88:89], v[104:105], v[250:251]
    v_pk_fma_f32 v[252:253], v[90:91], v[106:107], v[252:253]
    v_pk_fma_f32 v[254:255], v[92:93], v[108:109], v[254:255]
    v_pk_add_f32 v[118:119], v[248:249], v[250:251]
    v_pk_mul_f32 v[120:121], v[248:249], v[248:249]
    v_pk_add_f32 v[122:123], v[252:253], v[254:255]
    v_pk_fma_f32 v[120:121], v[250:251], v[250:251], v[120:121]
    v_pk_fma_f32 v[120:121], v[252:253], v[252:253], v[120:121]
    v_pk_fma_f32 v[120:121], v[254:255], v[254:255], v[120:121]
    v_pk_add_f32 v[118:119], v[118:119], v[122:123]
    v_add_f32 v120, v120, v121
    v_add_f32 v118, v118, v119
    s_nop 0
    v_add_f32_dpp v120, v120, v120 row_ror:8 row_mask:0xf bank_mask:0xf
    v_add_f32_dpp v118, v118, v118 row_ror:8 row_mask:0xf bank_mask:0xf
    s_nop 0
    v_add_f32_dpp v120, v120, v120 row_ror:4 row_mask:0xf bank_mask:0xf
    v_add_f32_dpp v118, v118, v118 row_ror:4 row_mask:0xf bank_mask:0xf
    s_nop 0
    v_add_f32_dpp v120, v120, v120 row_ror:2 row_mask:0xf bank_mask:0xf
    v_add_f32_dpp v118, v118, v118 row_ror:2 row_mask:0xf bank_mask:0xf
    s_nop 0
    v_add_f32_dpp v120, v120, v120 row_ror:1 row_mask:0xf bank_mask:0xf
    v_add_f32_dpp v118, v118, v118 row_ror:1 row_mask:0xf bank_mask:0xf
    s_nop 0
    v_add_f32_dpp v120, v120, v120 row_bcast:15 row_mask:0xa bank_mask:0xf
    v_add_f32_dpp v118, v118, v118 row_bcast:15 row_mask:0xa bank_mask:0xf
    s_nop 0
    v_add_f32_dpp v120, v120, v120 row_bcast:31 row_mask:0xc bank_mask:0xf
    v_add_f32_dpp v118, v118, v118 row_bcast:31 row_mask:0xc bank_mask:0xf
    v_mul_f32 v118, 0x3b000000, v118
    v_mul_f32 v120, 0x3b000000, v120
    v_fma_f32 v120, -v118, v118, v120
    v_max_f32 v120, 0, v120
    v_add_f32 v120, 0x3727c5ac, v120
    v_rsq_f32 v120, v120
    s_nop 0
    v_mul_f32 v120, 0x3fb8aa3b, v120
    v_mul_f32_e64 v118, -v118, v120
    v_readlane_b32 s36, v120, 63
    v_readlane_b32 s38, v118, 63
    s_nop 1
    v_mov_b32 v122, s38
    v_pk_fma_f32 v[102:103], v[248:249], s[36:37], v[122:123] op_sel_hi:[1,0,0]
    v_pk_fma_f32 v[104:105], v[250:251], s[36:37], v[122:123] op_sel_hi:[1,0,0]
    v_pk_fma_f32 v[106:107], v[252:253], s[36:37], v[122:123] op_sel_hi:[1,0,0]
    v_pk_fma_f32 v[108:109], v[254:255], s[36:37], v[122:123] op_sel_hi:[1,0,0]
    v_cvt_pk_bf16_f32 v110, v102, v103
    v_cvt_pk_bf16_f32 v111, v104, v105
    v_cvt_pk_bf16_f32 v112, v106, v107
    v_cvt_pk_bf16_f32 v113, v108, v109
    ds_write_b128 v130, v[110:113] offset:40448
    v_cvt_pk_bf16_f32 v114, v248, v249
    v_cvt_pk_bf16_f32 v115, v250, v251
    v_cvt_pk_bf16_f32 v116, v252, v253
    v_cvt_pk_bf16_f32 v117, v254, v255
    buffer_store_dwordx4 v[114:117], v0, s[76:79], s101 offen
    s_waitcnt lgkmcnt(0)
    s_barrier
    ds_read_b128 v[78:81], v131 offset:40448
    s_waitcnt lgkmcnt(0)
    buffer_store_dwordx4 v[78:81], v12, s[76:79], s26 offen
    v_mfma_f32_16x16x32_bf16 v[22:25], v[162:165], v[198:201], v[22:25]
    ds_read_b128 v[134:137], v19 offset:0
    ds_read_b128 v[138:141], v19 offset:1024
    v_mfma_f32_16x16x32_bf16 v[50:53], v[162:165], v[202:205], v[50:53]
    v_mfma_f32_16x16x32_bf16 v[26:29], v[166:169], v[198:201], v[26:29]
    ds_read_b128 v[142:145], v19 offset:2048
    ds_read_b128 v[146:149], v19 offset:3072
    v_mfma_f32_16x16x32_bf16 v[54:57], v[166:169], v[202:205], v[54:57]
    v_mfma_f32_16x16x32_bf16 v[30:33], v[170:173], v[198:201], v[30:33]
    ds_read_b128 v[150:153], v19 offset:4096
    ds_read_b128 v[154:157], v19 offset:5120
    v_mfma_f32_16x16x32_bf16 v[58:61], v[170:173], v[202:205], v[58:61]
    v_mfma_f32_16x16x32_bf16 v[34:37], v[174:177], v[198:201], v[34:37]
    ds_read_b128 v[158:161], v19 offset:6144
    buffer_load_dwordx4 v[190:193], v6, s[76:79], s89 offen offset:0 sc1
    v_mfma_f32_16x16x32_bf16 v[62:65], v[174:177], v[202:205], v[62:65]
    v_mfma_f32_16x16x32_bf16 v[38:41], v[178:181], v[198:201], v[38:41]
    buffer_load_dwordx4 v[194:197], v6, s[76:79], s89 offen offset:1024 sc1
    v_mfma_f32_16x16x32_bf16 v[66:69], v[178:181], v[202:205], v[66:69]
    v_mfma_f32_16x16x32_bf16 v[42:45], v[182:185], v[198:201], v[42:45]
    v_mfma_f32_16x16x32_bf16 v[70:73], v[182:185], v[202:205], v[70:73]
    v_mfma_f32_16x16x32_bf16 v[46:49], v[186:189], v[198:201], v[46:49]
    v_mfma_f32_16x16x32_bf16 v[74:77], v[186:189], v[202:205], v[74:77]
    s_waitcnt lgkmcnt(0)
    v_mfma_f32_16x16x32_bf16 v[22:25], v[134:137], v[206:209], v[22:25]
    ds_read_b128 v[162:165], v19 offset:7168
    ds_read_b128 v[166:169], v19 offset:8192
    v_mfma_f32_16x16x32_bf16 v[50:53], v[134:137], v[210:213], v[50:53]
    v_mfma_f32_16x16x32_bf16 v[26:29], v[138:141], v[206:209], v[26:29]
    ds_read_b128 v[170:173], v19 offset:9216
    ds_read_b128 v[174:177], v19 offset:10240
    v_mfma_f32_16x16x32_bf16 v[54:57], v[138:141], v[210:213], v[54:57]
    v_mfma_f32_16x16x32_bf16 v[30:33], v[142:145], v[206:209], v[30:33]
    ds_read_b128 v[178:181], v19 offset:11264
    ds_read_b128 v[182:185], v19 offset:12288
    v_mfma_f32_16x16x32_bf16 v[58:61], v[142:145], v[210:213], v[58:61]
    v_mfma_f32_16x16x32_bf16 v[34:37], v[146:149], v[206:209], v[34:37]
    ds_read_b128 v[186:189], v19 offset:13312
    buffer_load_dwordx4 v[198:201], v6, s[76:79], s89 offen offset:2048 sc1
    v_mfma_f32_16x16x32_bf16 v[62:65], v[146:149], v[210:213], v[62:65]
    v_mfma_f32_16x16x32_bf16 v[38:41], v[150:153], v[206:209], v[38:41]
    buffer_load_dwordx4 v[202:205], v6, s[76:79], s89 offen offset:3072 sc1
    v_mfma_f32_16x16x32_bf16 v[66:69], v[150:153], v[210:213], v[66:69]
    v_mfma_f32_16x16x32_bf16 v[42:45], v[154:157], v[206:209], v[42:45]
    v_mfma_f32_16x16x32_bf16 v[70:73], v[154:157], v[210:213], v[70:73]
    v_mfma_f32_16x16x32_bf16 v[46:49], v[158:161], v[206:209], v[46:49]
    v_mfma_f32_16x16x32_bf16 v[74:77], v[158:161], v[210:213], v[74:77]
    s_waitcnt lgkmcnt(0)
    v_mfma_f32_16x16x32_bf16 v[22:25], v[162:165], v[214:217], v[22:25]
    ds_read_b128 v[134:137], v19 offset:14336
    ds_read_b128 v[138:141], v19 offset:15360
    v_mfma_f32_16x16x32_bf16 v[50:53], v[162:165], v[218:221], v[50:53]
    v_mfma_f32_16x16x32_bf16 v[26:29], v[166:169], v[214:217], v[26:29]
    ds_read_b128 v[142:145], v19 offset:16384
    ds_read_b128 v[146:149], v19 offset:17408
    v_mfma_f32_16x16x32_bf16 v[54:57], v[166:169], v[218:221], v[54:57]
    v_mfma_f32_16x16x32_bf16 v[30:33], v[170:173], v[214:217], v[30:33]
    ds_read_b128 v[150:153], v19 offset:18432
    ds_read_b128 v[154:157], v19 offset:19456
    v_mfma_f32_16x16x32_bf16 v[58:61], v[170:173], v[218:221], v[58:61]
    v_mfma_f32_16x16x32_bf16 v[34:37], v[174:177], v[214:217], v[34:37]
    ds_read_b128 v[158:161], v19 offset:20480
    buffer_load_dwordx4 v[206:209], v6, s[76:79], s90 offen offset:0 sc1
    v_mfma_f32_16x16x32_bf16 v[62:65], v[174:177], v[218:221], v[62:65]
    v_mfma_f32_16x16x32_bf16 v[38:41], v[178:181], v[214:217], v[38:41]
    buffer_load_dwordx4 v[210:213], v6, s[76:79], s90 offen offset:1024 sc1
    s_waitcnt vmcnt(6)
    v_mfma_f32_16x16x32_bf16 v[66:69], v[178:181], v[218:221], v[66:69]
    s_cmp_lg_u32 s11, 0
    s_cbranch_scc1 L68
    buffer_store_dword v4, v3, s[76:79], s95 offen offset:1536
L69:
    v_mfma_f32_16x16x32_bf16 v[42:45], v[182:185], v[214:217], v[42:45]
    v_mfma_f32_16x16x32_bf16 v[70:73], v[182:185], v[218:221], v[70:73]
    v_mfma_f32_16x16x32_bf16 v[46:49], v[186:189], v[214:217], v[46:49]
    v_mfma_f32_16x16x32_bf16 v[74:77], v[186:189], v[218:221], v[74:77]
    s_waitcnt lgkmcnt(0)
    v_mfma_f32_16x16x32_bf16 v[22:25], v[134:137], a[224:227], v[22:25]
    ds_read_b128 v[162:165], v19 offset:21504
    ds_read_b128 v[166:169], v19 offset:22528
    v_mfma_f32_16x16x32_bf16 v[50:53], v[134:137], a[228:231], v[50:53]
    v_mfma_f32_16x16x32_bf16 v[26:29], v[138:141], a[224:227], v[26:29]
    ds_read_b128 v[170:173], v19 offset:23552
    ds_read_b128 v[174:177], v19 offset:24576
    v_mfma_f32_16x16x32_bf16 v[54:57], v[138:141], a[228:231], v[54:57]
    v_mfma_f32_16x16x32_bf16 v[30:33], v[142:145], a[224:227], v[30:33]
    ds_read_b128 v[178:181], v19 offset:25600
    ds_read_b128 v[182:185], v19 offset:26624
    v_mfma_f32_16x16x32_bf16 v[58:61], v[142:145], a[228:231], v[58:61]
    v_mfma_f32_16x16x32_bf16 v[34:37], v[146:149], a[224:227], v[34:37]
    ds_read_b128 v[186:189], v19 offset:27648
    buffer_load_dwordx4 v[214:217], v6, s[76:79], s90 offen offset:2048 sc1
    v_mfma_f32_16x16x32_bf16 v[62:65], v[146:149], a[228:231], v[62:65]
    v_mfma_f32_16x16x32_bf16 v[38:41], v[150:153], a[224:227], v[38:41]
    buffer_load_dwordx4 v[218:221], v6, s[76:79], s90 offen offset:3072 sc1
    v_mfma_f32_16x16x32_bf16 v[66:69], v[150:153], a[228:231], v[66:69]
    v_mfma_f32_16x16x32_bf16 v[42:45], v[154:157], a[224:227], v[42:45]
    buffer_load_dword v5, v17, s[76:79], s94 offen offset:1536 sc1
    v_mfma_f32_16x16x32_bf16 v[70:73], v[154:157], a[228:231], v[70:73]
    v_mfma_f32_16x16x32_bf16 v[46:49], v[158:161], a[224:227], v[46:49]
    v_mfma_f32_16x16x32_bf16 v[74:77], v[158:161], a[228:231], v[74:77]
    s_waitcnt lgkmcnt(0)
    v_mfma_f32_16x16x32_bf16 v[22:25], v[162:165], a[232:235], v[22:25]
    ds_read_b128 v[134:137], v19 offset:28672
    ds_read_b128 v[138:141], v19 offset:29696
    v_mfma_f32_16x16x32_bf16 v[50:53], v[162:165], a[236:239], v[50:53]
    v_mfma_f32_16x16x32_bf16 v[26:29], v[166:169], a[232:235], v[26:29]
    ds_read_b128 v[142:145], v19 offset:30720
    ds_read_b128 v[146:149], v19 offset:31744
    v_mfma_f32_16x16x32_bf16 v[54:57], v[166:169], a[236:239], v[54:57]
    v_mfma_f32_16x16x32_bf16 v[30:33], v[170:173], a[232:235], v[30:33]
    ds_read_b128 v[150:153], v19 offset:32768
    ds_read_b128 v[154:157], v19 offset:33792
    v_mfma_f32_16x16x32_bf16 v[58:61], v[170:173], a[236:239], v[58:61]
    v_mfma_f32_16x16x32_bf16 v[34:37], v[174:177], a[232:235], v[34:37]
    ds_read_b128 v[158:161], v19 offset:34816
    v_mfma_f32_16x16x32_bf16 v[62:65], v[174:177], a[236:239], v[62:65]
    v_mfma_f32_16x16x32_bf16 v[38:41], v[178:181], a[232:235], v[38:41]
    v_mfma_f32_16x16x32_bf16 v[66:69], v[178:181], a[236:239], v[66:69]
    v_mfma_f32_16x16x32_bf16 v[42:45], v[182:185], a[232:235], v[42:45]
    v_mfma_f32_16x16x32_bf16 v[70:73], v[182:185], a[236:239], v[70:73]
    v_mfma_f32_16x16x32_bf16 v[46:49], v[186:189], a[232:235], v[46:49]
    v_mfma_f32_16x16x32_bf16 v[74:77], v[186:189], a[236:239], v[74:77]
    s_waitcnt vmcnt(8) lgkmcnt(0)
    v_mfma_f32_16x16x32_bf16 v[22:25], v[134:137], v[190:193], v[22:25]
    ds_read_b128 v[162:165], v19 offset:35840
    ds_read_b128 v[166:169], v19 offset:36864
    v_mfma_f32_16x16x32_bf16 v[50:53], v[134:137], v[194:197], v[50:53]
    v_mfma_f32_16x16x32_bf16 v[26:29], v[138:141], v[190:193], v[26:29]
    ds_read_b128 v[170:173], v19 offset:37888
    ds_read_b128 v[174:177], v19 offset:38912
    v_mfma_f32_16x16x32_bf16 v[54:57], v[138:141], v[194:197], v[54:57]
    v_mfma_f32_16x16x32_bf16 v[30:33], v[142:145], v[190:193], v[30:33]
    ds_read_b128 v[178:181], v19 offset:39936
    ds_read_b128 v[182:185], v19 offset:40960
    v_mfma_f32_16x16x32_bf16 v[58:61], v[142:145], v[194:197], v[58:61]
    v_mfma_f32_16x16x32_bf16 v[34:37], v[146:149], v[190:193], v[34:37]
    ds_read_b128 v[186:189], v19 offset:41984
    v_mfma_f32_16x16x32_bf16 v[62:65], v[146:149], v[194:197], v[62:65]
    v_mfma_f32_16x16x32_bf16 v[38:41], v[150:153], v[190:193], v[38:41]
    v_mfma_f32_16x16x32_bf16 v[66:69], v[150:153], v[194:197], v[66:69]
    v_mfma_f32_16x16x32_bf16 v[42:45], v[154:157], v[190:193], v[42:45]
    s_waitcnt vmcnt(0)
    v_cmp_ne_u32 vcc, s8, v5
    v_mfma_f32_16x16x32_bf16 v[70:73], v[154:157], v[194:197], v[70:73]
    s_cbranch_vccnz L65
L66:
    v_mfma_f32_16x16x32_bf16 v[46:49], v[158:161], v[190:193], v[46:49]
    v_mfma_f32_16x16x32_bf16 v[74:77], v[158:161], v[194:197], v[74:77]
    s_waitcnt lgkmcnt(0)
    v_mfma_f32_16x16x32_bf16 v[22:25], v[162:165], v[198:201], v[22:25]
    ds_read_b128 v[134:137], v19 offset:43008
    ds_read_b128 v[138:141], v19 offset:44032
    v_mfma_f32_16x16x32_bf16 v[50:53], v[162:165], v[202:205], v[50:53]
    v_mfma_f32_16x16x32_bf16 v[26:29], v[166:169], v[198:201], v[26:29]
    ds_read_b128 v[142:145], v19 offset:45056
    ds_read_b128 v[146:149], v19 offset:46080
    v_mfma_f32_16x16x32_bf16 v[54:57], v[166:169], v[202:205], v[54:57]
    v_mfma_f32_16x16x32_bf16 v[30:33], v[170:173], v[198:201], v[30:33]
    ds_read_b128 v[150:153], v19 offset:47104
    ds_read_b128 v[154:157], v19 offset:48128
    v_mfma_f32_16x16x32_bf16 v[58:61], v[170:173], v[202:205], v[58:61]
    v_mfma_f32_16x16x32_bf16 v[34:37], v[174:177], v[198:201], v[34:37]
    ds_read_b128 v[158:161], v19 offset:49152
    buffer_load_dwordx4 a[224:227], v7, s[76:79], 0 offen offset:0 sc1
    v_mfma_f32_16x16x32_bf16 v[62:65], v[174:177], v[202:205], v[62:65]
    v_mfma_f32_16x16x32_bf16 v[38:41], v[178:181], v[198:201], v[38:41]
    buffer_load_dwordx4 a[228:231], v7, s[76:79], 0 offen offset:1024 sc1
    v_mfma_f32_16x16x32_bf16 v[66:69], v[178:181], v[202:205], v[66:69]
    v_mfma_f32_16x16x32_bf16 v[42:45], v[182:185], v[198:201], v[42:45]
    buffer_load_dwordx4 a[232:235], v7, s[76:79], 0 offen offset:2048 sc1
    v_mfma_f32_16x16x32_bf16 v[70:73], v[182:185], v[202:205], v[70:73]
    v_mfma_f32_16x16x32_bf16 v[46:49], v[186:189], v[198:201], v[46:49]
    buffer_load_dwordx4 a[236:239], v7, s[76:79], 0 offen offset:3072 sc1
    v_mfma_f32_16x16x32_bf16 v[74:77], v[186:189], v[202:205], v[74:77]
    s_waitcnt lgkmcnt(0)
    v_mfma_f32_16x16x32_bf16 v[22:25], v[134:137], v[206:209], v[22:25]
    ds_read_b128 v[162:165], v19 offset:50176
    ds_read_b128 v[166:169], v19 offset:51200
    v_mfma_f32_16x16x32_bf16 v[50:53], v[134:137], v[210:213], v[50:53]
    v_mfma_f32_16x16x32_bf16 v[26:29], v[138:141], v[206:209], v[26:29]
    ds_read_b128 v[170:173], v19 offset:52224
    ds_read_b128 v[174:177], v19 offset:53248
    v_mfma_f32_16x16x32_bf16 v[54:57], v[138:141], v[210:213], v[54:57]
    v_mfma_f32_16x16x32_bf16 v[30:33], v[142:145], v[206:209], v[30:33]
    ds_read_b128 v[178:181], v19 offset:54272
    ds_read_b128 v[182:185], v19 offset:55296
    v_mfma_f32_16x16x32_bf16 v[58:61], v[142:145], v[210:213], v[58:61]
    v_mfma_f32_16x16x32_bf16 v[34:37], v[146:149], v[206:209], v[34:37]
    ds_read_b128 v[186:189], v19 offset:56320
    buffer_load_dwordx4 v[190:193], v7, s[76:79], s84 offen offset:0 sc1
    v_mfma_f32_16x16x32_bf16 v[62:65], v[146:149], v[210:213], v[62:65]
    v_mfma_f32_16x16x32_bf16 v[38:41], v[150:153], v[206:209], v[38:41]
    buffer_load_dwordx4 v[194:197], v7, s[76:79], s84 offen offset:1024 sc1
    v_mfma_f32_16x16x32_bf16 v[66:69], v[150:153], v[210:213], v[66:69]
    v_mfma_f32_16x16x32_bf16 v[42:45], v[154:157], v[206:209], v[42:45]
    buffer_load_dwordx4 v[198:201], v7, s[76:79], s84 offen offset:2048 sc1
    v_mfma_f32_16x16x32_bf16 v[70:73], v[154:157], v[210:213], v[70:73]
    v_mfma_f32_16x16x32_bf16 v[46:49], v[158:161], v[206:209], v[46:49]
    buffer_load_dwordx4 v[202:205], v7, s[76:79], s84 offen offset:3072 sc1
    v_mfma_f32_16x16x32_bf16 v[74:77], v[158:161], v[210:213], v[74:77]
    s_waitcnt lgkmcnt(0)
    v_mfma_f32_16x16x32_bf16 v[22:25], v[162:165], v[214:217], v[22:25]
    ds_read_b128 v[134:137], v2 offset:0
    ds_read_b128 v[138:141], v2 offset:1024
    v_mfma_f32_16x16x32_bf16 v[50:53], v[162:165], v[218:221], v[50:53]
    v_mfma_f32_16x16x32_bf16 v[26:29], v[166:169], v[214:217], v[26:29]
    ds_read_b128 v[142:145], v2 offset:2048
    ds_read_b128 v[146:149], v2 offset:3072
    v_mfma_f32_16x16x32_bf16 v[54:57], v[166:169], v[218:221], v[54:57]
    v_mfma_f32_16x16x32_bf16 v[30:33], v[170:173], v[214:217], v[30:33]
    ds_read_b128 v[150:153], v2 offset:4096
    ds_read_b128 v[154:157], v2 offset:5120
    v_mfma_f32_16x16x32_bf16 v[58:61], v[170:173], v[218:221], v[58:61]
    v_mfma_f32_16x16x32_bf16 v[34:37], v[174:177], v[214:217], v[34:37]
    ds_read_b128 v[158:161], v2 offset:6144
    buffer_load_dwordx4 v[206:209], v7, s[76:79], s85 offen offset:0 sc1
    v_mfma_f32_16x16x32_bf16 v[62:65], v[174:177], v[218:221], v[62:65]
    v_mfma_f32_16x16x32_bf16 v[38:41], v[178:181], v[214:217], v[38:41]
    buffer_load_dwordx4 v[210:213], v7, s[76:79], s85 offen offset:1024 sc1
    v_mfma_f32_16x16x32_bf16 v[66:69], v[178:181], v[218:221], v[66:69]
    v_mfma_f32_16x16x32_bf16 v[42:45], v[182:185], v[214:217], v[42:45]
    v_mfma_f32_16x16x32_bf16 v[70:73], v[182:185], v[218:221], v[70:73]
    v_mfma_f32_16x16x32_bf16 v[46:49], v[186:189], v[214:217], v[46:49]
    v_mfma_f32_16x16x32_bf16 v[74:77], v[186:189], v[218:221], v[74:77]
    v_exp_f32_e64 v222, -v22
    v_pk_mul_f32 v[26:27], v[22:23], v[26:27]
    v_exp_f32_e64 v223, -v23
    v_pk_mul_f32 v[28:29], v[24:25], v[28:29]
    v_exp_f32_e64 v224, -v24
    v_pk_fma_f32 v[222:223], v[222:223], s[24:25], s[24:25]
    v_exp_f32_e64 v225, -v25
    v_rcp_f32 v222, v222
    v_pk_fma_f32 v[224:225], v[224:225], s[24:25], s[24:25]
    v_rcp_f32 v223, v223
    v_pk_mul_f32 v[34:35], v[30:31], v[34:35]
    v_rcp_f32 v224, v224
    v_pk_mul_f32 v[26:27], v[26:27], v[222:223]
    v_rcp_f32 v225, v225
    v_cvt_pk_bf16_f32 v22, v26, v27
    v_pk_mul_f32 v[28:29], v[28:29], v[224:225]
    v_exp_f32_e64 v226, -v30
    v_cvt_pk_bf16_f32 v23, v28, v29
    v_exp_f32_e64 v227, -v31
    v_exp_f32_e64 v228, -v32
    v_pk_mul_f32 v[36:37], v[32:33], v[36:37]
    v_exp_f32_e64 v229, -v33
    v_pk_fma_f32 v[226:227], v[226:227], s[24:25], s[24:25]
    v_pk_fma_f32 v[228:229], v[228:229], s[24:25], s[24:25]
    v_rcp_f32 v226, v226
    v_rcp_f32 v227, v227
    v_pk_mul_f32 v[42:43], v[38:39], v[42:43]
    v_rcp_f32 v228, v228
    v_pk_mul_f32 v[34:35], v[34:35], v[226:227]
    v_rcp_f32 v229, v229
    v_cvt_pk_bf16_f32 v24, v34, v35
    v_pk_mul_f32 v[36:37], v[36:37], v[228:229]
    v_exp_f32_e64 v222, -v38
    v_cvt_pk_bf16_f32 v25, v36, v37
    v_exp_f32_e64 v223, -v39
    buffer_store_dwordx4 v[22:25], v10, s[76:79], 0 offen offset:0 sc1
    v_exp_f32_e64 v224, -v40
    v_exp_f32_e64 v225, -v41
    v_pk_mul_f32 v[44:45], v[40:41], v[44:45]
    v_pk_fma_f32 v[222:223], v[222:223], s[24:25], s[24:25]
    v_rcp_f32 v222, v222
    v_pk_fma_f32 v[224:225], v[224:225], s[24:25], s[24:25]
    v_rcp_f32 v223, v223
    v_rcp_f32 v224, v224
    v_pk_mul_f32 v[42:43], v[42:43], v[222:223]
    v_rcp_f32 v225, v225
    v_cvt_pk_bf16_f32 v30, v42, v43
    v_pk_mul_f32 v[44:45], v[44:45], v[224:225]
    v_exp_f32_e64 v226, -v46
    v_cvt_pk_bf16_f32 v31, v44, v45
    v_exp_f32_e64 v227, -v47
    v_pk_mul_f32 v[48:49], v[46:47], v[48:49]
    v_pk_fma_f32 v[226:227], v[226:227], s[24:25], s[24:25]
    v_mov_b32 v27, v30
    v_rcp_f32 v226, v226
    v_mov_b32 v28, v31
    v_rcp_f32 v227, v227
    s_nop 0
    v_pk_mul_f32 v[48:49], v[48:49], v[226:227]
    v_cvt_pk_bf16_f32 v32, v48, v49
    v_mov_b32 v26, v32
    v_permlane32_swap_b32 v28, v33
    s_nop 0
    v_permlane32_swap_b32 v27, v26
    s_nop 1
    v_permlane16_swap_b32 v26, v33
    buffer_store_dwordx4 v[30:33], v11, s[76:79], 0 offen offset:0 sc1
    s_waitcnt vmcnt(10) lgkmcnt(0)
    v_mfma_f32_16x16x32_bf16 v[78:81], v[134:137], a[224:227], 0
    ds_read_b128 v[162:165], v2 offset:7168
    ds_read_b128 v[166:169], v2 offset:8192
    v_mfma_f32_16x16x32_bf16 v[106:109], v[134:137], a[228:231], 0
    v_mfma_f32_16x16x32_bf16 v[82:85], v[138:141], a[224:227], 0
    ds_read_b128 v[170:173], v2 offset:9216
    ds_read_b128 v[174:177], v2 offset:10240
    v_mfma_f32_16x16x32_bf16 v[110:113], v[138:141], a[228:231], 0
    v_mfma_f32_16x16x32_bf16 v[86:89], v[142:145], a[224:227], 0
    ds_read_b128 v[178:181], v2 offset:11264
    ds_read_b128 v[182:185], v2 offset:12288
    v_mfma_f32_16x16x32_bf16 v[114:117], v[142:145], a[228:231], 0
    v_exp_f32_e64 v222, -v50
    v_mfma_f32_16x16x32_bf16 v[90:93], v[146:149], a[224:227], 0
    ds_read_b128 v[186:189], v2 offset:13312
    buffer_load_dwordx4 v[214:217], v7, s[76:79], s85 offen offset:2048 sc1
    v_mfma_f32_16x16x32_bf16 v[118:121], v[146:149], a[228:231], 0
    v_exp_f32_e64 v223, -v51
    v_mfma_f32_16x16x32_bf16 v[94:97], v[150:153], a[224:227], 0
    buffer_load_dwordx4 v[218:221], v7, s[76:79], s85 offen offset:3072 sc1
    v_mul_f32 v54, v50, v54
    v_mfma_f32_16x16x32_bf16 v[122:125], v[150:153], a[228:231], 0
    v_exp_f32_e64 v224, -v52
    v_mfma_f32_16x16x32_bf16 v[98:101], v[154:157], a[224:227], 0
    v_exp_f32_e64 v225, -v53
    v_mfma_f32_16x16x32_bf16 v[126:129], v[154:157], a[228:231], 0
    v_mul_f32 v55, v51, v55
    v_mul_f32 v56, v52, v56
    v_mfma_f32_16x16x32_bf16 v[102:105], v[158:161], a[224:227], 0
    v_mul_f32 v57, v53, v57
    v_fma_f32 v222, v222, s24, s24
    v_mfma_f32_16x16x32_bf16 v[130:133], v[158:161], a[228:231], 0
    v_fma_f32 v223, v223, s24, s24
    s_waitcnt vmcnt(10) lgkmcnt(0)
    v_mfma_f32_16x16x32_bf16 v[78:81], v[162:165], a[232:235], v[78:81]
    ds_read_b128 v[134:137], v2 offset:14336
    ds_read_b128 v[138:141], v2 offset:15360
    v_mfma_f32_16x16x32_bf16 v[106:109], v[162:165], a[236:239], v[106:109]
    v_rcp_f32 v222, v222
    v_mfma_f32_16x16x32_bf16 v[82:85], v[166:169], a[232:235], v[82:85]
    ds_read_b128 v[142:145], v2 offset:16384
    ds_read_b128 v[146:149], v2 offset:17408
    v_mfma_f32_16x16x32_bf16 v[110:113], v[166:169], a[236:239], v[110:113]
    v_rcp_f32 v223, v223
    v_mfma_f32_16x16x32_bf16 v[86:89], v[170:173], a[232:235], v[86:89]
    ds_read_b128 v[150:153], v2 offset:18432
    ds_read_b128 v[154:157], v2 offset:19456
    v_mfma_f32_16x16x32_bf16 v[114:117], v[170:173], a[236:239], v[114:117]
    v_exp_f32_e64 v226, -v58
    v_mfma_f32_16x16x32_bf16 v[90:93], v[174:177], a[232:235], v[90:93]
    ds_read_b128 v[158:161], v2 offset:20480
    buffer_load_dwordx4 a[224:227], v7, s[76:79], s86 offen offset:0 sc1
    v_mfma_f32_16x16x32_bf16 v[118:121], v[174:177], a[236:239], v[118:121]
    v_exp_f32_e64 v227, -v59
    v_mfma_f32_16x16x32_bf16 v[94:97], v[178:181], a[232:235], v[94:97]
    buffer_load_dwordx4 a[228:231], v7, s[76:79], s86 offen offset:1024 sc1
    v_fma_f32 v224, v224, s24, s24
    v_mfma_f32_16x16x32_bf16 v[122:125], v[178:181], a[236:239], v[122:125]
    v_rcp_f32 v224, v224
    v_mfma_f32_16x16x32_bf16 v[98:101], v[182:185], a[232:235], v[98:101]
    v_exp_f32_e64 v228, -v60
    v_mfma_f32_16x16x32_bf16 v[126:129], v[182:185], a[236:239], v[126:129]
    v_exp_f32_e64 v229, -v61
    v_mfma_f32_16x16x32_bf16 v[102:105], v[186:189], a[232:235], v[102:105]
    v_fma_f32 v225, v225, s24, s24
    v_mul_f32 v54, v54, v222
    v_mfma_f32_16x16x32_bf16 v[130:133], v[186:189], a[236:239], v[130:133]
    v_mul_f32 v55, v55, v223
    s_waitcnt vmcnt(10) lgkmcnt(0)
    v_mfma_f32_16x16x32_bf16 v[78:81], v[134:137], v[190:193], v[78:81]
    ds_read_b128 v[162:165], v2 offset:21504
    ds_read_b128 v[166:169], v2 offset:22528
    v_mfma_f32_16x16x32_bf16 v[106:109], v[134:137], v[194:197], v[106:109]
    v_rcp_f32 v225, v225
    v_mfma_f32_16x16x32_bf16 v[82:85], v[138:141], v[190:193], v[82:85]
    ds_read_b128 v[170:173], v2 offset:23552
    ds_read_b128 v[174:177], v2 offset:24576
    v_mfma_f32_16x16x32_bf16 v[110:113], v[138:141], v[194:197], v[110:113]
    v_mul_f32 v56, v56, v224
    v_mul_f32 v57, v57, v225
    v_mfma_f32_16x16x32_bf16 v[86:89], v[142:145], v[190:193], v[86:89]
    ds_read_b128 v[178:181], v2 offset:25600
    ds_read_b128 v[182:185], v2 offset:26624
    v_mfma_f32_16x16x32_bf16 v[114:117], v[142:145], v[194:197], v[114:117]
    v_cvt_pk_bf16_f32 v50, v54, v55
    v_cvt_pk_bf16_f32 v51, v56, v57
    v_mfma_f32_16x16x32_bf16 v[90:93], v[146:149], v[190:193], v[90:93]
    ds_read_b128 v[186:189], v2 offset:27648
    buffer_load_dwordx4 a[232:235], v7, s[76:79], s86 offen offset:2048 sc1
    v_mfma_f32_16x16x32_bf16 v[118:121], v[146:149], v[194:197], v[118:121]
    v_mul_f32 v62, v58, v62
    v_mul_f32 v63, v59, v63
    v_mfma_f32_16x16x32_bf16 v[94:97], v[150:153], v[190:193], v[94:97]
    buffer_load_dwordx4 a[236:239], v7, s[76:79], s86 offen offset:3072 sc1
    v_mul_f32 v64, v60, v64
    v_mfma_f32_16x16x32_bf16 v[122:125], v[150:153], v[194:197], v[122:125]
    v_mul_f32 v65, v61, v65
    v_fma_f32 v226, v226, s24, s24
    v_mfma_f32_16x16x32_bf16 v[98:101], v[154:157], v[190:193], v[98:101]
    v_rcp_f32 v226, v226
    v_mfma_f32_16x16x32_bf16 v[126:129], v[154:157], v[194:197], v[126:129]
    v_exp_f32_e64 v222, -v66
    v_mfma_f32_16x16x32_bf16 v[102:105], v[158:161], v[190:193], v[102:105]
    v_exp_f32_e64 v223, -v67
    v_mfma_f32_16x16x32_bf16 v[130:133], v[158:161], v[194:197], v[130:133]
    v_fma_f32 v227, v227, s24, s24
    s_waitcnt vmcnt(10) lgkmcnt(0)
    v_mfma_f32_16x16x32_bf16 v[78:81], v[162:165], v[198:201], v[78:81]
    ds_read_b128 v[134:137], v2 offset:28672
    ds_read_b128 v[138:141], v2 offset:29696
    v_mfma_f32_16x16x32_bf16 v[106:109], v[162:165], v[202:205], v[106:109]
    v_rcp_f32 v227, v227
    v_mfma_f32_16x16x32_bf16 v[82:85], v[166:169], v[198:201], v[82:85]
    ds_read_b128 v[142:145], v2 offset:30720
    ds_read_b128 v[146:149], v2 offset:31744
    v_mfma_f32_16x16x32_bf16 v[110:113], v[166:169], v[202:205], v[110:113]
    v_exp_f32_e64 v224, -v68
    v_mfma_f32_16x16x32_bf16 v[86:89], v[170:173], v[198:201], v[86:89]
    ds_read_b128 v[150:153], v2 offset:32768
    ds_read_b128 v[154:157], v2 offset:33792
    v_mfma_f32_16x16x32_bf16 v[114:117], v[170:173], v[202:205], v[114:117]
    v_exp_f32_e64 v225, -v69
    v_mfma_f32_16x16x32_bf16 v[90:93], v[174:177], v[198:201], v[90:93]
    ds_read_b128 v[158:161], v2 offset:34816
    buffer_load_dwordx4 v[190:193], v7, s[76:79], s87 offen offset:0 sc1
    v_mfma_f32_16x16x32_bf16 v[118:121], v[174:177], v[202:205], v[118:121]
    v_fma_f32 v228, v228, s24, s24
    v_fma_f32 v229, v229, s24, s24
    v_mfma_f32_16x16x32_bf16 v[94:97], v[178:181], v[198:201], v[94:97]
    buffer_load_dwordx4 v[194:197], v7, s[76:79], s87 offen offset:1024 sc1
    v_mul_f32 v62, v62, v226
    v_mfma_f32_16x16x32_bf16 v[122:125], v[178:181], v[202:205], v[122:125]
    v_rcp_f32 v228, v228
    v_mfma_f32_16x16x32_bf16 v[98:101], v[182:185], v[198:201], v[98:101]
    v_rcp_f32 v229, v229
    v_mfma_f32_16x16x32_bf16 v[126:129], v[182:185], v[202:205], v[126:129]
    v_mul_f32 v63, v63, v227
    v_mul_f32 v64, v64, v228
    v_mfma_f32_16x16x32_bf16 v[102:105], v[186:189], v[198:201], v[102:105]
    v_mul_f32 v65, v65, v229
    v_cvt_pk_bf16_f32 v52, v62, v63
    v_mfma_f32_16x16x32_bf16 v[130:133], v[186:189], v[202:205], v[130:133]
    v_cvt_pk_bf16_f32 v53, v64, v65
    s_waitcnt vmcnt(10) lgkmcnt(0)
    v_mfma_f32_16x16x32_bf16 v[78:81], v[134:137], v[206:209], v[78:81]
    ds_read_b128 v[162:165], v2 offset:35840
    ds_read_b128 v[166:169], v2 offset:36864
    v_mfma_f32_16x16x32_bf16 v[106:109], v[134:137], v[210:213], v[106:109]
    buffer_store_dwordx4 v[50:53], v10, s[76:79], 0 offen offset:256 sc1
    v_mul_f32 v70, v66, v70
    v_mfma_f32_16x16x32_bf16 v[82:85], v[138:141], v[206:209], v[82:85]
    ds_read_b128 v[170:173], v2 offset:37888
    ds_read_b128 v[174:177], v2 offset:38912
    v_mfma_f32_16x16x32_bf16 v[110:113], v[138:141], v[210:213], v[110:113]
    v_mul_f32 v71, v67, v71
    v_mul_f32 v72, v68, v72
    v_mfma_f32_16x16x32_bf16 v[86:89], v[142:145], v[206:209], v[86:89]
    ds_read_b128 v[178:181], v2 offset:39936
    ds_read_b128 v[182:185], v2 offset:40960
    v_mfma_f32_16x16x32_bf16 v[114:117], v[142:145], v[210:213], v[114:117]
    v_mul_f32 v73, v69, v73
    v_fma_f32 v222, v222, s24, s24
    v_mfma_f32_16x16x32_bf16 v[90:93], v[146:149], v[206:209], v[90:93]
    ds_read_b128 v[186:189], v2 offset:41984
    buffer_load_dwordx4 v[198:201], v7, s[76:79], s87 offen offset:2048 sc1
    v_mfma_f32_16x16x32_bf16 v[118:121], v[146:149], v[210:213], v[118:121]
    v_rcp_f32 v222, v222
    v_mfma_f32_16x16x32_bf16 v[94:97], v[150:153], v[206:209], v[94:97]
    buffer_load_dwordx4 v[202:205], v7, s[76:79], s87 offen offset:3072 sc1
    v_fma_f32 v223, v223, s24, s24
    v_mfma_f32_16x16x32_bf16 v[122:125], v[150:153], v[210:213], v[122:125]
    v_rcp_f32 v223, v223
    v_mfma_f32_16x16x32_bf16 v[98:101], v[154:157], v[206:209], v[98:101]
    v_exp_f32_e64 v226, -v74
    v_mfma_f32_16x16x32_bf16 v[126:129], v[154:157], v[210:213], v[126:129]
    v_exp_f32_e64 v227, -v75
    v_mfma_f32_16x16x32_bf16 v[102:105], v[158:161], v[206:209], v[102:105]
    v_fma_f32 v224, v224, s24, s24
    v_fma_f32 v225, v225, s24, s24
    v_mfma_f32_16x16x32_bf16 v[130:133], v[158:161], v[210:213], v[130:133]
    v_mul_f32 v70, v70, v222
    s_waitcnt vmcnt(9) lgkmcnt(0)
    v_mfma_f32_16x16x32_bf16 v[78:81], v[162:165], v[214:217], v[78:81]
    ds_read_b128 v[134:137], v2 offset:43008
    ds_read_b128 v[138:141], v2 offset:44032
    v_mfma_f32_16x16x32_bf16 v[106:109], v[162:165], v[218:221], v[106:109]
    v_rcp_f32 v224, v224
    v_mfma_f32_16x16x32_bf16 v[82:85], v[166:169], v[214:217], v[82:85]
    ds_read_b128 v[142:145], v2 offset:45056
    ds_read_b128 v[146:149], v2 offset:46080
    v_mfma_f32_16x16x32_bf16 v[110:113], v[166:169], v[218:221], v[110:113]
    v_rcp_f32 v225, v225
    v_mfma_f32_16x16x32_bf16 v[86:89], v[170:173], v[214:217], v[86:89]
    ds_read_b128 v[150:153], v2 offset:47104
    ds_read_b128 v[154:157], v2 offset:48128
    v_mfma_f32_16x16x32_bf16 v[114:117], v[170:173], v[218:221], v[114:117]
    v_mul_f32 v71, v71, v223
    v_mul_f32 v72, v72, v224
    v_mfma_f32_16x16x32_bf16 v[90:93], v[174:177], v[214:217], v[90:93]
    ds_read_b128 v[158:161], v2 offset:49152
    buffer_load_dwordx4 v[206:209], v7, s[76:79], s88 offen offset:0 sc1
    v_mfma_f32_16x16x32_bf16 v[118:121], v[174:177], v[218:221], v[118:121]
    v_mul_f32 v73, v73, v225
    v_cvt_pk_bf16_f32 v58, v70, v71
    v_mfma_f32_16x16x32_bf16 v[94:97], v[178:181], v[214:217], v[94:97]
    buffer_load_dwordx4 v[210:213], v7, s[76:79], s88 offen offset:1024 sc1
    v_cvt_pk_bf16_f32 v59, v72, v73
    v_mfma_f32_16x16x32_bf16 v[122:125], v[178:181], v[218:221], v[122:125]
    v_mul_f32 v76, v74, v76
    v_mul_f32 v77, v75, v77
    v_mfma_f32_16x16x32_bf16 v[98:101], v[182:185], v[214:217], v[98:101]
    v_fma_f32 v226, v226, s24, s24
    v_fma_f32 v227, v227, s24, s24
    v_mfma_f32_16x16x32_bf16 v[126:129], v[182:185], v[218:221], v[126:129]
    v_rcp_f32 v226, v226
    v_mfma_f32_16x16x32_bf16 v[102:105], v[186:189], v[214:217], v[102:105]
    v_rcp_f32 v227, v227
    v_mfma_f32_16x16x32_bf16 v[130:133], v[186:189], v[218:221], v[130:133]
    v_mul_f32 v76, v76, v226
    s_waitcnt vmcnt(9) lgkmcnt(0)
    v_mfma_f32_16x16x32_bf16 v[78:81], v[134:137], a[224:227], v[78:81]
    ds_read_b128 v[162:165], v2 offset:50176
    ds_read_b128 v[166:169], v2 offset:51200
    v_mfma_f32_16x16x32_bf16 v[106:109], v[134:137], a[228:231], v[106:109]
    v_mul_f32 v77, v77, v227
    v_mfma_f32_16x16x32_bf16 v[82:85], v[138:141], a[224:227], v[82:85]
    ds_read_b128 v[170:173], v2 offset:52224
    ds_read_b128 v[174:177], v2 offset:53248
    v_mfma_f32_16x16x32_bf16 v[110:113], v[138:141], a[228:231], v[110:113]
    s_cmp_lg_u32 s11, 0
    s_cbranch_scc1 L73
    buffer_store_dword v4, v3, s[76:79], s97 offen offset:2048
L74:
    v_mfma_f32_16x16x32_bf16 v[86:89], v[142:145], a[224:227], v[86:89]
    ds_read_b128 v[178:181], v2 offset:54272
    ds_read_b128 v[182:185], v2 offset:55296
    v_mfma_f32_16x16x32_bf16 v[114:117], v[142:145], a[228:231], v[114:117]
    v_cvt_pk_bf16_f32 v60, v76, v77
    v_mov_b32 v55, v58
    v_mfma_f32_16x16x32_bf16 v[90:93], v[146:149], a[224:227], v[90:93]
    ds_read_b128 v[186:189], v2 offset:56320
    buffer_load_dwordx4 v[214:217], v7, s[76:79], s88 offen offset:2048 sc1
    v_mfma_f32_16x16x32_bf16 v[118:121], v[146:149], a[228:231], v[118:121]
    v_mov_b32 v56, v59
    v_mov_b32 v54, v60
    v_mfma_f32_16x16x32_bf16 v[94:97], v[150:153], a[224:227], v[94:97]
    buffer_load_dwordx4 v[218:221], v7, s[76:79], s88 offen offset:3072 sc1
    v_permlane32_swap_b32 v56, v61
    v_mfma_f32_16x16x32_bf16 v[122:125], v[150:153], a[228:231], v[122:125]
    v_permlane32_swap_b32 v55, v54
    v_mfma_f32_16x16x32_bf16 v[98:101], v[154:157], a[224:227], v[98:101]
    v_mfma_f32_16x16x32_bf16 v[126:129], v[154:157], a[228:231], v[126:129]
    v_permlane16_swap_b32 v54, v61
    buffer_store_dwordx4 v[58:61], v11, s[76:79], 0 offen offset:256 sc1
    v_mfma_f32_16x16x32_bf16 v[102:105], v[158:161], a[224:227], v[102:105]
    v_mfma_f32_16x16x32_bf16 v[130:133], v[158:161], a[228:231], v[130:133]
    s_waitcnt vmcnt(11) lgkmcnt(0)
    v_mfma_f32_16x16x32_bf16 v[78:81], v[162:165], a[232:235], v[78:81]
    ds_read_b128 v[134:137], v19 offset:0
    ds_read_b128 v[138:141], v19 offset:1024
    v_mfma_f32_16x16x32_bf16 v[106:109], v[162:165], a[236:239], v[106:109]
    v_mfma_f32_16x16x32_bf16 v[82:85], v[166:169], a[232:235], v[82:85]
    ds_read_b128 v[142:145], v19 offset:2048
    ds_read_b128 v[146:149], v19 offset:3072
    v_mfma_f32_16x16x32_bf16 v[110:113], v[166:169], a[236:239], v[110:113]
    v_mfma_f32_16x16x32_bf16 v[86:89], v[170:173], a[232:235], v[86:89]
    ds_read_b128 v[150:153], v19 offset:4096
    ds_read_b128 v[154:157], v19 offset:5120
    v_mfma_f32_16x16x32_bf16 v[114:117], v[170:173], a[236:239], v[114:117]
    v_mfma_f32_16x16x32_bf16 v[90:93], v[174:177], a[232:235], v[90:93]
    ds_read_b128 v[158:161], v19 offset:6144
    buffer_load_dwordx4 a[224:227], v7, s[76:79], s89 offen offset:0 sc1
    v_mfma_f32_16x16x32_bf16 v[118:121], v[174:177], a[236:239], v[118:121]
    v_mfma_f32_16x16x32_bf16 v[94:97], v[178:181], a[232:235], v[94:97]
    buffer_load_dwordx4 a[228:231], v7, s[76:79], s89 offen offset:1024 sc1
    v_mfma_f32_16x16x32_bf16 v[122:125], v[178:181], a[236:239], v[122:125]
    v_mfma_f32_16x16x32_bf16 v[98:101], v[182:185], a[232:235], v[98:101]
    v_mfma_f32_16x16x32_bf16 v[126:129], v[182:185], a[236:239], v[126:129]
    v_mfma_f32_16x16x32_bf16 v[102:105], v[186:189], a[232:235], v[102:105]
    v_mfma_f32_16x16x32_bf16 v[130:133], v[186:189], a[236:239], v[130:133]
    s_waitcnt vmcnt(11) lgkmcnt(0)
    v_mfma_f32_16x16x32_bf16 v[78:81], v[134:137], v[190:193], v[78:81]
    ds_read_b128 v[162:165], v19 offset:7168
    ds_read_b128 v[166:169], v19 offset:8192
    v_mfma_f32_16x16x32_bf16 v[106:109], v[134:137], v[194:197], v[106:109]
    v_mfma_f32_16x16x32_bf16 v[82:85], v[138:141], v[190:193], v[82:85]
    ds_read_b128 v[170:173], v19 offset:9216
    ds_read_b128 v[174:177], v19 offset:10240
    v_mfma_f32_16x16x32_bf16 v[110:113], v[138:141], v[194:197], v[110:113]
    v_mfma_f32_16x16x32_bf16 v[86:89], v[142:145], v[190:193], v[86:89]
    ds_read_b128 v[178:181], v19 offset:11264
    ds_read_b128 v[182:185], v19 offset:12288
    v_mfma_f32_16x16x32_bf16 v[114:117], v[142:145], v[194:197], v[114:117]
    v_mfma_f32_16x16x32_bf16 v[90:93], v[146:149], v[190:193], v[90:93]
    ds_read_b128 v[186:189], v19 offset:13312
    buffer_load_dwordx4 a[232:235], v7, s[76:79], s89 offen offset:2048 sc1
    v_mfma_f32_16x16x32_bf16 v[118:121], v[146:149], v[194:197], v[118:121]
    v_mfma_f32_16x16x32_bf16 v[94:97], v[150:153], v[190:193], v[94:97]
    buffer_load_dwordx4 a[236:239], v7, s[76:79], s89 offen offset:3072 sc1
    v_mfma_f32_16x16x32_bf16 v[122:125], v[150:153], v[194:197], v[122:125]
    v_mfma_f32_16x16x32_bf16 v[98:101], v[154:157], v[190:193], v[98:101]
    v_mfma_f32_16x16x32_bf16 v[126:129], v[154:157], v[194:197], v[126:129]
    v_mfma_f32_16x16x32_bf16 v[102:105], v[158:161], v[190:193], v[102:105]
    buffer_load_dword v5, v18, s[76:79], s96 offen offset:2048 sc1
    v_mfma_f32_16x16x32_bf16 v[130:133], v[158:161], v[194:197], v[130:133]
    s_waitcnt vmcnt(11) lgkmcnt(0)
    v_mfma_f32_16x16x32_bf16 v[78:81], v[162:165], v[198:201], v[78:81]
    ds_read_b128 v[134:137], v19 offset:14336
    ds_read_b128 v[138:141], v19 offset:15360
    v_mfma_f32_16x16x32_bf16 v[106:109], v[162:165], v[202:205], v[106:109]
    v_mfma_f32_16x16x32_bf16 v[82:85], v[166:169], v[198:201], v[82:85]
    ds_read_b128 v[142:145], v19 offset:16384
    ds_read_b128 v[146:149], v19 offset:17408
    v_mfma_f32_16x16x32_bf16 v[110:113], v[166:169], v[202:205], v[110:113]
    v_mfma_f32_16x16x32_bf16 v[86:89], v[170:173], v[198:201], v[86:89]
    ds_read_b128 v[150:153], v19 offset:18432
    ds_read_b128 v[154:157], v19 offset:19456
    v_mfma_f32_16x16x32_bf16 v[114:117], v[170:173], v[202:205], v[114:117]
    v_mfma_f32_16x16x32_bf16 v[90:93], v[174:177], v[198:201], v[90:93]
    ds_read_b128 v[158:161], v19 offset:20480
    buffer_load_dwordx4 v[190:193], v7, s[76:79], s90 offen offset:0 sc1
    v_mfma_f32_16x16x32_bf16 v[118:121], v[174:177], v[202:205], v[118:121]
    v_mfma_f32_16x16x32_bf16 v[94:97], v[178:181], v[198:201], v[94:97]
    buffer_load_dwordx4 v[194:197], v7, s[76:79], s90 offen offset:1024 sc1
    v_mfma_f32_16x16x32_bf16 v[122:125], v[178:181], v[202:205], v[122:125]
    v_mfma_f32_16x16x32_bf16 v[98:101], v[182:185], v[198:201], v[98:101]
    v_mfma_f32_16x16x32_bf16 v[126:129], v[182:185], v[202:205], v[126:129]
    v_mfma_f32_16x16x32_bf16 v[102:105], v[186:189], v[198:201], v[102:105]
    v_mfma_f32_16x16x32_bf16 v[130:133], v[186:189], v[202:205], v[130:133]
    s_waitcnt vmcnt(11) lgkmcnt(0)
    v_mfma_f32_16x16x32_bf16 v[78:81], v[134:137], v[206:209], v[78:81]
    ds_read_b128 v[162:165], v19 offset:21504
    ds_read_b128 v[166:169], v19 offset:22528
    v_mfma_f32_16x16x32_bf16 v[106:109], v[134:137], v[210:213], v[106:109]
    v_mfma_f32_16x16x32_bf16 v[82:85], v[138:141], v[206:209], v[82:85]
    ds_read_b128 v[170:173], v19 offset:23552
    ds_read_b128 v[174:177], v19 offset:24576
    v_mfma_f32_16x16x32_bf16 v[110:113], v[138:141], v[210:213], v[110:113]
    v_mfma_f32_16x16x32_bf16 v[86:89], v[142:145], v[206:209], v[86:89]
    ds_read_b128 v[178:181], v19 offset:25600
    ds_read_b128 v[182:185], v19 offset:26624
    v_mfma_f32_16x16x32_bf16 v[114:117], v[142:145], v[210:213], v[114:117]
    v_mfma_f32_16x16x32_bf16 v[90:93], v[146:149], v[206:209], v[90:93]
    ds_read_b128 v[186:189], v19 offset:27648
    buffer_load_dwordx4 v[198:201], v7, s[76:79], s90 offen offset:2048 sc1
    v_mfma_f32_16x16x32_bf16 v[118:121], v[146:149], v[210:213], v[118:121]
    v_mfma_f32_16x16x32_bf16 v[94:97], v[150:153], v[206:209], v[94:97]
    buffer_load_dwordx4 v[202:205], v7, s[76:79], s90 offen offset:3072 sc1
    v_mfma_f32_16x16x32_bf16 v[122:125], v[150:153], v[210:213], v[122:125]
    v_mfma_f32_16x16x32_bf16 v[98:101], v[154:157], v[206:209], v[98:101]
    v_mfma_f32_16x16x32_bf16 v[126:129], v[154:157], v[210:213], v[126:129]
    v_mfma_f32_16x16x32_bf16 v[102:105], v[158:161], v[206:209], v[102:105]
    s_waitcnt vmcnt(4)
    v_cmp_ne_u32 vcc, s8, v5
    v_mfma_f32_16x16x32_bf16 v[130:133], v[158:161], v[210:213], v[130:133]
    s_cbranch_vccnz L70
L71:
    s_waitcnt lgkmcnt(0)
    v_mfma_f32_16x16x32_bf16 v[78:81], v[162:165], v[214:217], v[78:81]
    ds_read_b128 v[134:137], v19 offset:28672
    ds_read_b128 v[138:141], v19 offset:29696
    v_mfma_f32_16x16x32_bf16 v[106:109], v[162:165], v[218:221], v[106:109]
    buffer_load_dwordx4 v[22:25], v8, s[76:79], 0 offen offset:0 sc1
    v_mfma_f32_16x16x32_bf16 v[82:85], v[166:169], v[214:217], v[82:85]
    ds_read_b128 v[142:145], v19 offset:30720
    ds_read_b128 v[146:149], v19 offset:31744
    v_mfma_f32_16x16x32_bf16 v[110:113], v[166:169], v[218:221], v[110:113]
    buffer_load_dwordx4 v[26:29], v8, s[76:79], 0 offen offset:2048 sc1
    v_mfma_f32_16x16x32_bf16 v[86:89], v[170:173], v[214:217], v[86:89]
    ds_read_b128 v[150:153], v19 offset:32768
    ds_read_b128 v[154:157], v19 offset:33792
    v_mfma_f32_16x16x32_bf16 v[114:117], v[170:173], v[218:221], v[114:117]
    v_mfma_f32_16x16x32_bf16 v[90:93], v[174:177], v[214:217], v[90:93]
    ds_read_b128 v[158:161], v19 offset:34816
    buffer_load_dwordx4 v[30:33], v8, s[76:79], s84 offen offset:0 sc1
    v_mfma_f32_16x16x32_bf16 v[118:121], v[174:177], v[218:221], v[118:121]
    v_mfma_f32_16x16x32_bf16 v[94:97], v[178:181], v[214:217], v[94:97]
    v_mfma_f32_16x16x32_bf16 v[122:125], v[178:181], v[218:221], v[122:125]
    v_mfma_f32_16x16x32_bf16 v[98:101], v[182:185], v[214:217], v[98:101]
    buffer_load_dwordx4 v[34:37], v8, s[76:79], s84 offen offset:2048 sc1
    v_mfma_f32_16x16x32_bf16 v[126:129], v[182:185], v[218:221], v[126:129]
    v_mfma_f32_16x16x32_bf16 v[102:105], v[186:189], v[214:217], v[102:105]
    v_mfma_f32_16x16x32_bf16 v[130:133], v[186:189], v[218:221], v[130:133]
    s_waitcnt lgkmcnt(0)
    v_mfma_f32_16x16x32_bf16 v[78:81], v[134:137], a[224:227], v[78:81]
    ds_read_b128 v[162:165], v19 offset:35840
    ds_read_b128 v[166:169], v19 offset:36864
    v_mfma_f32_16x16x32_bf16 v[106:109], v[134:137], a[228:231], v[106:109]
    buffer_load_dwordx4 v[38:41], v8, s[76:79], s85 offen offset:0 sc1
    v_mfma_f32_16x16x32_bf16 v[82:85], v[138:141], a[224:227], v[82:85]
    ds_read_b128 v[170:173], v19 offset:37888
    ds_read_b128 v[174:177], v19 offset:38912
    v_mfma_f32_16x16x32_bf16 v[110:113], v[138:141], a[228:231], v[110:113]
    s_cmp_lg_u32 s11, 0
    s_cbranch_scc1 L75
    buffer_store_dword v4, v3, s[76:79], s97 offen offset:2560
L76:
    v_mfma_f32_16x16x32_bf16 v[86:89], v[142:145], a[224:227], v[86:89]
    ds_read_b128 v[178:181], v19 offset:39936
    ds_read_b128 v[182:185], v19 offset:40960
    v_mfma_f32_16x16x32_bf16 v[114:117], v[142:145], a[228:231], v[114:117]
    buffer_load_dwordx4 v[42:45], v8, s[76:79], s85 offen offset:2048 sc1
    v_mfma_f32_16x16x32_bf16 v[90:93], v[146:149], a[224:227], v[90:93]
    ds_read_b128 v[186:189], v19 offset:41984
    v_mfma_f32_16x16x32_bf16 v[118:121], v[146:149], a[228:231], v[118:121]
    v_mfma_f32_16x16x32_bf16 v[94:97], v[150:153], a[224:227], v[94:97]
    buffer_load_dwordx4 v[46:49], v8, s[76:79], s86 offen offset:0 sc1
    v_mfma_f32_16x16x32_bf16 v[122:125], v[150:153], a[228:231], v[122:125]
    v_mfma_f32_16x16x32_bf16 v[98:101], v[154:157], a[224:227], v[98:101]
    v_mfma_f32_16x16x32_bf16 v[126:129], v[154:157], a[228:231], v[126:129]
    v_mfma_f32_16x16x32_bf16 v[102:105], v[158:161], a[224:227], v[102:105]
    v_mfma_f32_16x16x32_bf16 v[130:133], v[158:161], a[228:231], v[130:133]
    s_waitcnt lgkmcnt(0)
    v_mfma_f32_16x16x32_bf16 v[78:81], v[162:165], a[232:235], v[78:81]
    ds_read_b128 v[134:137], v19 offset:43008
    ds_read_b128 v[138:141], v19 offset:44032
    v_mfma_f32_16x16x32_bf16 v[106:109], v[162:165], a[236:239], v[106:109]
    v_mfma_f32_16x16x32_bf16 v[82:85], v[166:169], a[232:235], v[82:85]
    ds_read_b128 v[142:145], v19 offset:45056
    ds_read_b128 v[146:149], v19 offset:46080
    v_mfma_f32_16x16x32_bf16 v[110:113], v[166:169], a[236:239], v[110:113]
    v_mfma_f32_16x16x32_bf16 v[86:89], v[170:173], a[232:235], v[86:89]
    ds_read_b128 v[150:153], v19 offset:47104
    ds_read_b128 v[154:157], v19 offset:48128
    v_mfma_f32_16x16x32_bf16 v[114:117], v[170:173], a[236:239], v[114:117]
    buffer_load_dwordx4 v[50:53], v8, s[76:79], s86 offen offset:2048 sc1
    v_mfma_f32_16x16x32_bf16 v[90:93], v[174:177], a[232:235], v[90:93]
    ds_read_b128 v[158:161], v19 offset:49152
    v_mfma_f32_16x16x32_bf16 v[118:121], v[174:177], a[236:239], v[118:121]
    v_mfma_f32_16x16x32_bf16 v[94:97], v[178:181], a[232:235], v[94:97]
    buffer_load_dwordx4 v[54:57], v8, s[76:79], s87 offen offset:0 sc1
    v_mfma_f32_16x16x32_bf16 v[122:125], v[178:181], a[236:239], v[122:125]
    v_mfma_f32_16x16x32_bf16 v[98:101], v[182:185], a[232:235], v[98:101]
    v_mfma_f32_16x16x32_bf16 v[126:129], v[182:185], a[236:239], v[126:129]
    v_mfma_f32_16x16x32_bf16 v[102:105], v[186:189], a[232:235], v[102:105]
    buffer_load_dwordx4 v[58:61], v8, s[76:79], s87 offen offset:2048 sc1
    v_mfma_f32_16x16x32_bf16 v[130:133], v[186:189], a[236:239], v[130:133]
    s_waitcnt vmcnt(13) lgkmcnt(0)
    v_mfma_f32_16x16x32_bf16 v[78:81], v[134:137], v[190:193], v[78:81]
    ds_read_b128 v[162:165], v19 offset:50176
    ds_read_b128 v[166:169], v19 offset:51200
    v_mfma_f32_16x16x32_bf16 v[106:109], v[134:137], v[194:197], v[106:109]
    v_mfma_f32_16x16x32_bf16 v[82:85], v[138:141], v[190:193], v[82:85]
    ds_read_b128 v[170:173], v19 offset:52224
    ds_read_b128 v[174:177], v19 offset:53248
    v_mfma_f32_16x16x32_bf16 v[110:113], v[138:141], v[194:197], v[110:113]
    buffer_load_dwordx4 v[62:65], v8, s[76:79], s88 offen offset:0 sc1
    v_mfma_f32_16x16x32_bf16 v[86:89], v[142:145], v[190:193], v[86:89]
    ds_read_b128 v[178:181], v19 offset:54272
    ds_read_b128 v[182:185], v19 offset:55296
    v_mfma_f32_16x16x32_bf16 v[114:117], v[142:145], v[194:197], v[114:117]
    v_mfma_f32_16x16x32_bf16 v[90:93], v[146:149], v[190:193], v[90:93]
    ds_read_b128 v[186:189], v19 offset:56320
    buffer_load_dwordx4 v[66:69], v8, s[76:79], s88 offen offset:2048 sc1
    v_mfma_f32_16x16x32_bf16 v[118:121], v[146:149], v[194:197], v[118:121]
    v_mfma_f32_16x16x32_bf16 v[94:97], v[150:153], v[190:193], v[94:97]
    v_mfma_f32_16x16x32_bf16 v[122:125], v[150:153], v[194:197], v[122:125]
    v_mfma_f32_16x16x32_bf16 v[98:101], v[154:157], v[190:193], v[98:101]
    buffer_load_dwordx4 v[70:73], v8, s[76:79], s89 offen offset:0 sc1
    v_mfma_f32_16x16x32_bf16 v[126:129], v[154:157], v[194:197], v[126:129]
    v_mfma_f32_16x16x32_bf16 v[102:105], v[158:161], v[190:193], v[102:105]
    v_mfma_f32_16x16x32_bf16 v[130:133], v[158:161], v[194:197], v[130:133]
    s_waitcnt vmcnt(14) lgkmcnt(0)
    v_mfma_f32_16x16x32_bf16 v[78:81], v[162:165], v[198:201], v[78:81]
    buffer_load_dwordx4 v[74:77], v8, s[76:79], s89 offen offset:2048 sc1
    v_mfma_f32_16x16x32_bf16 v[106:109], v[162:165], v[202:205], v[106:109]
    v_mfma_f32_16x16x32_bf16 v[82:85], v[166:169], v[198:201], v[82:85]
    v_mfma_f32_16x16x32_bf16 v[110:113], v[166:169], v[202:205], v[110:113]
    v_mfma_f32_16x16x32_bf16 v[86:89], v[170:173], v[198:201], v[86:89]
    v_mfma_f32_16x16x32_bf16 v[114:117], v[170:173], v[202:205], v[114:117]
    v_mfma_f32_16x16x32_bf16 v[90:93], v[174:177], v[198:201], v[90:93]
    v_mfma_f32_16x16x32_bf16 v[118:121], v[174:177], v[202:205], v[118:121]
    v_mfma_f32_16x16x32_bf16 v[94:97], v[178:181], v[198:201], v[94:97]
    v_mfma_f32_16x16x32_bf16 v[122:125], v[178:181], v[202:205], v[122:125]
    v_mfma_f32_16x16x32_bf16 v[98:101], v[182:185], v[198:201], v[98:101]
    v_mfma_f32_16x16x32_bf16 v[126:129], v[182:185], v[202:205], v[126:129]
    v_mfma_f32_16x16x32_bf16 v[102:105], v[186:189], v[198:201], v[102:105]
    v_mfma_f32_16x16x32_bf16 v[130:133], v[186:189], v[202:205], v[130:133]
    v_exp_f32_e64 v222, -v78
    v_pk_mul_f32 v[82:83], v[78:79], v[82:83]
    v_exp_f32_e64 v223, -v79
    v_pk_mul_f32 v[84:85], v[80:81], v[84:85]
    v_exp_f32_e64 v224, -v80
    v_pk_fma_f32 v[222:223], v[222:223], s[24:25], s[24:25]
    v_exp_f32_e64 v225, -v81
    v_rcp_f32 v222, v222
    v_pk_fma_f32 v[224:225], v[224:225], s[24:25], s[24:25]
    v_rcp_f32 v223, v223
    v_pk_mul_f32 v[90:91], v[86:87], v[90:91]
    v_rcp_f32 v224, v224
    v_pk_mul_f32 v[82:83], v[82:83], v[222:223]
    v_rcp_f32 v225, v225
    v_cvt_pk_bf16_f32 v78, v82, v83
    v_pk_mul_f32 v[84:85], v[84:85], v[224:225]
    v_exp_f32_e64 v226, -v86
    v_cvt_pk_bf16_f32 v79, v84, v85
    v_exp_f32_e64 v227, -v87
    v_exp_f32_e64 v228, -v88
    v_pk_mul_f32 v[92:93], v[88:89], v[92:93]
    v_exp_f32_e64 v229, -v89
    v_pk_fma_f32 v[226:227], v[226:227], s[24:25], s[24:25]
    v_pk_fma_f32 v[228:229], v[228:229], s[24:25], s[24:25]
    v_rcp_f32 v226, v226
    v_rcp_f32 v227, v227
    v_pk_mul_f32 v[98:99], v[94:95], v[98:99]
    v_rcp_f32 v228, v228
    v_pk_mul_f32 v[90:91], v[90:91], v[226:227]
    v_rcp_f32 v229, v229
    v_cvt_pk_bf16_f32 v80, v90, v91
    v_pk_mul_f32 v[92:93], v[92:93], v[228:229]
    v_exp_f32_e64 v222, -v94
    v_cvt_pk_bf16_f32 v81, v92, v93
    v_exp_f32_e64 v223, -v95
    buffer_store_dwordx4 v[78:81], v10, s[76:79], s91 offen offset:0 sc1
    v_exp_f32_e64 v224, -v96
    v_exp_f32_e64 v225, -v97
    v_pk_mul_f32 v[100:101], v[96:97], v[100:101]
    v_pk_fma_f32 v[222:223], v[222:223], s[24:25], s[24:25]
    v_rcp_f32 v222, v222
    buffer_load_dword v5, v18, s[76:79], s96 offen offset:2560 sc1
    v_pk_fma_f32 v[224:225], v[224:225], s[24:25], s[24:25]
    v_rcp_f32 v223, v223
    v_rcp_f32 v224, v224
    v_pk_mul_f32 v[98:99], v[98:99], v[222:223]
    v_rcp_f32 v225, v225
    v_cvt_pk_bf16_f32 v86, v98, v99
    v_pk_mul_f32 v[100:101], v[100:101], v[224:225]
    v_exp_f32_e64 v226, -v102
    v_cvt_pk_bf16_f32 v87, v100, v101
    v_exp_f32_e64 v227, -v103
    v_pk_mul_f32 v[104:105], v[102:103], v[104:105]
    v_pk_fma_f32 v[226:227], v[226:227], s[24:25], s[24:25]
    v_mov_b32 v83, v86
    v_rcp_f32 v226, v226
    v_mov_b32 v84, v87
    v_rcp_f32 v227, v227
    v_pk_mul_f32 v[110:111], v[106:107], v[110:111]
    v_pk_mul_f32 v[104:105], v[104:105], v[226:227]
    v_exp_f32_e64 v222, -v106
    v_cvt_pk_bf16_f32 v88, v104, v105
    v_exp_f32_e64 v223, -v107
    v_mov_b32 v82, v88
    v_exp_f32_e64 v224, -v108
    v_permlane32_swap_b32 v84, v89
    v_exp_f32_e64 v225, -v109
    v_permlane32_swap_b32 v83, v82
    v_pk_mul_f32 v[112:113], v[108:109], v[112:113]
    v_pk_fma_f32 v[222:223], v[222:223], s[24:25], s[24:25]
    v_permlane16_swap_b32 v82, v89
    v_rcp_f32 v222, v222
    buffer_store_dwordx4 v[86:89], v11, s[76:79], s91 offen offset:0 sc1
    v_rcp_f32 v223, v223
    v_pk_fma_f32 v[224:225], v[224:225], s[24:25], s[24:25]
    v_rcp_f32 v224, v224
    v_rcp_f32 v225, v225
    v_pk_mul_f32 v[110:111], v[110:111], v[222:223]
    v_pk_mul_f32 v[112:113], v[112:113], v[224:225]
    v_exp_f32_e64 v226, -v114
    v_cvt_pk_bf16_f32 v106, v110, v111
    v_exp_f32_e64 v227, -v115
    v_cvt_pk_bf16_f32 v107, v112, v113
    v_exp_f32_e64 v228, -v116
    v_exp_f32_e64 v229, -v117
    v_pk_mul_f32 v[118:119], v[114:115], v[118:119]
    v_pk_mul_f32 v[120:121], v[116:117], v[120:121]
    v_exp_f32_e64 v222, -v122
    v_pk_fma_f32 v[226:227], v[226:227], s[24:25], s[24:25]
    v_rcp_f32 v226, v226
    v_pk_fma_f32 v[228:229], v[228:229], s[24:25], s[24:25]
    v_rcp_f32 v227, v227
    v_rcp_f32 v228, v228
    v_pk_mul_f32 v[118:119], v[118:119], v[226:227]
    v_rcp_f32 v229, v229
    v_cvt_pk_bf16_f32 v108, v118, v119
    v_pk_mul_f32 v[120:121], v[120:121], v[228:229]
    v_exp_f32_e64 v223, -v123
    v_cvt_pk_bf16_f32 v109, v120, v121
    v_exp_f32_e64 v224, -v124
    buffer_store_dwordx4 v[106:109], v10, s[76:79], s91 offen offset:256 sc1
    v_exp_f32_e64 v225, -v125
    v_pk_mul_f32 v[126:127], v[122:123], v[126:127]
    v_exp_f32_e64 v226, -v130
    v_pk_mul_f32 v[128:129], v[124:125], v[128:129]
    v_exp_f32_e64 v227, -v131
    v_pk_fma_f32 v[222:223], v[222:223], s[24:25], s[24:25]
    v_rcp_f32 v222, v222
    v_pk_fma_f32 v[224:225], v[224:225], s[24:25], s[24:25]
    v_rcp_f32 v223, v223
    v_rcp_f32 v224, v224
    v_pk_mul_f32 v[126:127], v[126:127], v[222:223]
    v_rcp_f32 v225, v225
    v_cvt_pk_bf16_f32 v114, v126, v127
    v_pk_mul_f32 v[128:129], v[128:129], v[224:225]
    v_cvt_pk_bf16_f32 v115, v128, v129
    v_pk_mul_f32 v[132:133], v[130:131], v[132:133]
    v_pk_fma_f32 v[226:227], v[226:227], s[24:25], s[24:25]
    v_rcp_f32 v226, v226
    v_rcp_f32 v227, v227
    v_mov_b32 v111, v114
    v_pk_mul_f32 v[132:133], v[132:133], v[226:227]
    v_cvt_pk_bf16_f32 v116, v132, v133
    v_mov_b32 v112, v115
    v_mov_b32 v110, v116
    s_nop 0
    v_permlane32_swap_b32 v112, v117
    v_permlane32_swap_b32 v111, v110
    s_nop 1
    v_permlane16_swap_b32 v110, v117
    buffer_store_dwordx4 v[114:117], v11, s[76:79], s91 offen offset:256 sc1
    s_waitcnt vmcnt(18)
    v_mfma_f32_16x16x32_bf16 v[190:193], a[0:3], v[22:25], 0
    s_waitcnt vmcnt(3)
    v_cmp_ne_u32 vcc, s8, v5
    v_mfma_f32_16x16x32_bf16 v[194:197], a[4:7], v[22:25], 0
    s_cbranch_vccnz L77
L78:
    v_mfma_f32_16x16x32_bf16 v[198:201], a[8:11], v[22:25], 0
    v_mfma_f32_16x16x32_bf16 v[202:205], a[12:15], v[22:25], 0
    v_mfma_f32_16x16x32_bf16 v[190:193], a[16:19], v[26:29], v[190:193]
    buffer_load_dwordx4 v[134:137], v8, s[76:79], 0 offen offset:256 sc1
    v_mfma_f32_16x16x32_bf16 v[194:197], a[20:23], v[26:29], v[194:197]
    v_mfma_f32_16x16x32_bf16 v[198:201], a[24:27], v[26:29], v[198:201]
    v_mfma_f32_16x16x32_bf16 v[202:205], a[28:31], v[26:29], v[202:205]
    v_mfma_f32_16x16x32_bf16 v[190:193], a[32:35], v[30:33], v[190:193]
    buffer_load_dwordx4 v[138:141], v8, s[76:79], 0 offen offset:2304 sc1
    v_mfma_f32_16x16x32_bf16 v[194:197], a[36:39], v[30:33], v[194:197]
    v_mfma_f32_16x16x32_bf16 v[198:201], a[40:43], v[30:33], v[198:201]
    v_mfma_f32_16x16x32_bf16 v[202:205], a[44:47], v[30:33], v[202:205]
    v_mfma_f32_16x16x32_bf16 v[190:193], a[48:51], v[34:37], v[190:193]
    buffer_load_dwordx4 v[142:145], v8, s[76:79], s84 offen offset:256 sc1
    v_mfma_f32_16x16x32_bf16 v[194:197], a[52:55], v[34:37], v[194:197]
    v_mfma_f32_16x16x32_bf16 v[198:201], a[56:59], v[34:37], v[198:201]
    v_mfma_f32_16x16x32_bf16 v[202:205], a[60:63], v[34:37], v[202:205]
    v_mfma_f32_16x16x32_bf16 v[190:193], a[64:67], v[38:41], v[190:193]
    buffer_load_dwordx4 v[146:149], v8, s[76:79], s84 offen offset:2304 sc1
    v_mfma_f32_16x16x32_bf16 v[194:197], a[68:71], v[38:41], v[194:197]
    v_mfma_f32_16x16x32_bf16 v[198:201], a[72:75], v[38:41], v[198:201]
    v_mfma_f32_16x16x32_bf16 v[202:205], a[76:79], v[38:41], v[202:205]
    v_mfma_f32_16x16x32_bf16 v[190:193], a[80:83], v[42:45], v[190:193]
    buffer_load_dwordx4 v[150:153], v8, s[76:79], s85 offen offset:256 sc1
    v_mfma_f32_16x16x32_bf16 v[194:197], a[84:87], v[42:45], v[194:197]
    s_waitcnt vmcnt(7)
    v_mfma_f32_16x16x32_bf16 v[198:201], a[88:91], v[42:45], v[198:201]
    s_cmp_lg_u32 s11, 0
    s_cbranch_scc1 L86
    buffer_store_dword v4, v3, s[76:79], s97 offen offset:3072
L87:
    v_mfma_f32_16x16x32_bf16 v[202:205], a[92:95], v[42:45], v[202:205]
    v_mfma_f32_16x16x32_bf16 v[190:193], a[96:99], v[46:49], v[190:193]
    buffer_load_dwordx4 v[154:157], v8, s[76:79], s85 offen offset:2304 sc1
    v_mfma_f32_16x16x32_bf16 v[194:197], a[100:103], v[46:49], v[194:197]
    v_mfma_f32_16x16x32_bf16 v[198:201], a[104:107], v[46:49], v[198:201]
    v_mfma_f32_16x16x32_bf16 v[202:205], a[108:111], v[46:49], v[202:205]
    v_mfma_f32_16x16x32_bf16 v[190:193], a[112:115], v[50:53], v[190:193]
    buffer_load_dwordx4 v[158:161], v8, s[76:79], s86 offen offset:256 sc1
    v_mfma_f32_16x16x32_bf16 v[194:197], a[116:119], v[50:53], v[194:197]
    v_mfma_f32_16x16x32_bf16 v[198:201], a[120:123], v[50:53], v[198:201]
    v_mfma_f32_16x16x32_bf16 v[202:205], a[124:127], v[50:53], v[202:205]
    v_mfma_f32_16x16x32_bf16 v[190:193], a[128:131], v[54:57], v[190:193]
    buffer_load_dwordx4 v[162:165], v8, s[76:79], s86 offen offset:2304 sc1
    v_mfma_f32_16x16x32_bf16 v[194:197], a[132:135], v[54:57], v[194:197]
    v_mfma_f32_16x16x32_bf16 v[198:201], a[136:139], v[54:57], v[198:201]
    v_mfma_f32_16x16x32_bf16 v[202:205], a[140:143], v[54:57], v[202:205]
    v_mfma_f32_16x16x32_bf16 v[190:193], a[144:147], v[58:61], v[190:193]
    buffer_load_dwordx4 v[166:169], v8, s[76:79], s87 offen offset:256 sc1
    v_mfma_f32_16x16x32_bf16 v[194:197], a[148:151], v[58:61], v[194:197]
    v_mfma_f32_16x16x32_bf16 v[198:201], a[152:155], v[58:61], v[198:201]
    v_mfma_f32_16x16x32_bf16 v[202:205], a[156:159], v[58:61], v[202:205]
    v_mfma_f32_16x16x32_bf16 v[190:193], a[160:163], v[62:65], v[190:193]
    buffer_load_dwordx4 v[170:173], v8, s[76:79], s87 offen offset:2304 sc1
    v_mfma_f32_16x16x32_bf16 v[194:197], a[164:167], v[62:65], v[194:197]
    v_mfma_f32_16x16x32_bf16 v[198:201], a[168:171], v[62:65], v[198:201]
    v_mfma_f32_16x16x32_bf16 v[202:205], a[172:175], v[62:65], v[202:205]
    v_mfma_f32_16x16x32_bf16 v[190:193], a[176:179], v[66:69], v[190:193]
    buffer_load_dwordx4 v[174:177], v8, s[76:79], s88 offen offset:256 sc1
    v_mfma_f32_16x16x32_bf16 v[194:197], a[180:183], v[66:69], v[194:197]
    v_mfma_f32_16x16x32_bf16 v[198:201], a[184:187], v[66:69], v[198:201]
    v_mfma_f32_16x16x32_bf16 v[202:205], a[188:191], v[66:69], v[202:205]
    v_mfma_f32_16x16x32_bf16 v[190:193], a[192:195], v[70:73], v[190:193]
    buffer_load_dwordx4 v[178:181], v8, s[76:79], s88 offen offset:2304 sc1
    v_mfma_f32_16x16x32_bf16 v[194:197], a[196:199], v[70:73], v[194:197]
    buffer_load_dword v5, v18, s[76:79], s96 offen offset:3072 sc1
    v_mfma_f32_16x16x32_bf16 v[198:201], a[200:203], v[70:73], v[198:201]
    s_waitcnt vmcnt(14)
    v_mfma_f32_16x16x32_bf16 v[202:205], a[204:207], v[70:73], v[202:205]
    s_cmp_lg_u32 s11, 0
    s_cbranch_scc1 L88
    buffer_store_dword v4, v3, s[76:79], s97 offen offset:3584
L89:
    v_mfma_f32_16x16x32_bf16 v[190:193], a[208:211], v[74:77], v[190:193]
    buffer_load_dwordx4 v[182:185], v8, s[76:79], s89 offen offset:256 sc1
    v_mfma_f32_16x16x32_bf16 v[194:197], a[212:215], v[74:77], v[194:197]
    v_mfma_f32_16x16x32_bf16 v[198:201], a[216:219], v[74:77], v[198:201]
    v_mfma_f32_16x16x32_bf16 v[202:205], a[220:223], v[74:77], v[202:205]
    s_waitcnt vmcnt(14)
    v_mfma_f32_16x16x32_bf16 v[206:209], a[0:3], v[134:137], 0
    buffer_load_dwordx4 v[186:189], v8, s[76:79], s89 offen offset:2304 sc1
    v_mfma_f32_16x16x32_bf16 v[210:213], a[4:7], v[134:137], 0
    v_mfma_f32_16x16x32_bf16 v[214:217], a[8:11], v[134:137], 0
    v_mfma_f32_16x16x32_bf16 v[218:221], a[12:15], v[134:137], 0
    v_mfma_f32_16x16x32_bf16 v[206:209], a[16:19], v[138:141], v[206:209]
    v_mfma_f32_16x16x32_bf16 v[210:213], a[20:23], v[138:141], v[210:213]
    v_mfma_f32_16x16x32_bf16 v[214:217], a[24:27], v[138:141], v[214:217]
    v_mfma_f32_16x16x32_bf16 v[218:221], a[28:31], v[138:141], v[218:221]
    s_waitcnt vmcnt(13)
    v_mfma_f32_16x16x32_bf16 v[206:209], a[32:35], v[142:145], v[206:209]
    v_mfma_f32_16x16x32_bf16 v[210:213], a[36:39], v[142:145], v[210:213]
    v_mfma_f32_16x16x32_bf16 v[214:217], a[40:43], v[142:145], v[214:217]
    v_mfma_f32_16x16x32_bf16 v[218:221], a[44:47], v[142:145], v[218:221]
    v_mfma_f32_16x16x32_bf16 v[206:209], a[48:51], v[146:149], v[206:209]
    v_mfma_f32_16x16x32_bf16 v[210:213], a[52:55], v[146:149], v[210:213]
    v_mfma_f32_16x16x32_bf16 v[214:217], a[56:59], v[146:149], v[214:217]
    v_mfma_f32_16x16x32_bf16 v[218:221], a[60:63], v[146:149], v[218:221]
    s_waitcnt vmcnt(10)
    v_mfma_f32_16x16x32_bf16 v[206:209], a[64:67], v[150:153], v[206:209]
    v_mfma_f32_16x16x32_bf16 v[210:213], a[68:71], v[150:153], v[210:213]
    v_mfma_f32_16x16x32_bf16 v[214:217], a[72:75], v[150:153], v[214:217]
    s_waitcnt vmcnt(3)
    v_cmp_ne_u32 vcc, s8, v5
    v_mfma_f32_16x16x32_bf16 v[218:221], a[76:79], v[150:153], v[218:221]
    s_cbranch_vccnz L80
L81:
    v_mfma_f32_16x16x32_bf16 v[206:209], a[80:83], v[154:157], v[206:209]
    buffer_load_dwordx4 v[78:81], v9, s[76:79], 0 offen offset:0 sc1
    v_mfma_f32_16x16x32_bf16 v[210:213], a[84:87], v[154:157], v[210:213]
    v_mfma_f32_16x16x32_bf16 v[214:217], a[88:91], v[154:157], v[214:217]
    buffer_load_dword v5, v18, s[76:79], s96 offen offset:3584 sc1
    v_mfma_f32_16x16x32_bf16 v[218:221], a[92:95], v[154:157], v[218:221]
    v_mfma_f32_16x16x32_bf16 v[206:209], a[96:99], v[158:161], v[206:209]
    buffer_load_dwordx4 v[82:85], v9, s[76:79], 0 offen offset:2048 sc1
    v_mfma_f32_16x16x32_bf16 v[210:213], a[100:103], v[158:161], v[210:213]
    v_mfma_f32_16x16x32_bf16 v[214:217], a[104:107], v[158:161], v[214:217]
    v_mfma_f32_16x16x32_bf16 v[218:221], a[108:111], v[158:161], v[218:221]
    v_mfma_f32_16x16x32_bf16 v[206:209], a[112:115], v[162:165], v[206:209]
    buffer_load_dwordx4 v[86:89], v9, s[76:79], s84 offen offset:0 sc1
    v_mfma_f32_16x16x32_bf16 v[210:213], a[116:119], v[162:165], v[210:213]
    v_mfma_f32_16x16x32_bf16 v[214:217], a[120:123], v[162:165], v[214:217]
    v_mfma_f32_16x16x32_bf16 v[218:221], a[124:127], v[162:165], v[218:221]
    v_mfma_f32_16x16x32_bf16 v[206:209], a[128:131], v[166:169], v[206:209]
    buffer_load_dwordx4 v[90:93], v9, s[76:79], s84 offen offset:2048 sc1
    v_mfma_f32_16x16x32_bf16 v[210:213], a[132:135], v[166:169], v[210:213]
    v_mfma_f32_16x16x32_bf16 v[214:217], a[136:139], v[166:169], v[214:217]
    v_mfma_f32_16x16x32_bf16 v[218:221], a[140:143], v[166:169], v[218:221]
    v_mfma_f32_16x16x32_bf16 v[206:209], a[144:147], v[170:173], v[206:209]
    buffer_load_dwordx4 v[94:97], v9, s[76:79], s85 offen offset:0 sc1
    v_mfma_f32_16x16x32_bf16 v[210:213], a[148:151], v[170:173], v[210:213]
    v_mfma_f32_16x16x32_bf16 v[214:217], a[152:155], v[170:173], v[214:217]
    v_mfma_f32_16x16x32_bf16 v[218:221], a[156:159], v[170:173], v[218:221]
    v_mfma_f32_16x16x32_bf16 v[206:209], a[160:163], v[174:177], v[206:209]
    buffer_load_dwordx4 v[98:101], v9, s[76:79], s85 offen offset:2048 sc1
    buffer_load_dwordx4 v[222:225], v13, s[76:79], 0 offen sc1
    v_mfma_f32_16x16x32_bf16 v[210:213], a[164:167], v[174:177], v[210:213]
    v_mfma_f32_16x16x32_bf16 v[214:217], a[168:171], v[174:177], v[214:217]
    v_mfma_f32_16x16x32_bf16 v[218:221], a[172:175], v[174:177], v[218:221]
    v_mfma_f32_16x16x32_bf16 v[206:209], a[176:179], v[178:181], v[206:209]
    buffer_load_dwordx4 v[102:105], v9, s[76:79], s86 offen offset:0 sc1
    v_mfma_f32_16x16x32_bf16 v[210:213], a[180:183], v[178:181], v[210:213]
    v_mfma_f32_16x16x32_bf16 v[214:217], a[184:187], v[178:181], v[214:217]
    v_mfma_f32_16x16x32_bf16 v[218:221], a[188:191], v[178:181], v[218:221]
    s_waitcnt vmcnt(7)
    v_mfma_f32_16x16x32_bf16 v[206:209], a[192:195], v[182:185], v[206:209]
    buffer_load_dwordx4 v[106:109], v9, s[76:79], s86 offen offset:2048 sc1
    v_cmp_ne_u32 vcc, s8, v5
    v_mfma_f32_16x16x32_bf16 v[210:213], a[196:199], v[182:185], v[210:213]
    s_cbranch_vccnz L83
L84:
    v_mfma_f32_16x16x32_bf16 v[214:217], a[200:203], v[182:185], v[214:217]
    v_mfma_f32_16x16x32_bf16 v[218:221], a[204:207], v[182:185], v[218:221]
    v_mfma_f32_16x16x32_bf16 v[206:209], a[208:211], v[186:189], v[206:209]
    buffer_load_dwordx4 v[110:113], v9, s[76:79], s87 offen offset:0 sc1
    v_mfma_f32_16x16x32_bf16 v[210:213], a[212:215], v[186:189], v[210:213]
    v_mfma_f32_16x16x32_bf16 v[214:217], a[216:219], v[186:189], v[214:217]
    v_mfma_f32_16x16x32_bf16 v[218:221], a[220:223], v[186:189], v[218:221]
    s_waitcnt vmcnt(8)
    v_mfma_f32_16x16x32_bf16 v[134:137], a[0:3], v[78:81], 0
    buffer_load_dwordx4 v[114:117], v9, s[76:79], s87 offen offset:2048 sc1
    v_mfma_f32_16x16x32_bf16 v[138:141], a[4:7], v[78:81], 0
    v_mfma_f32_16x16x32_bf16 v[142:145], a[8:11], v[78:81], 0
    v_mfma_f32_16x16x32_bf16 v[146:149], a[12:15], v[78:81], 0
    ds_write_b128 v15, v[190:193] offset:0
    v_mfma_f32_16x16x32_bf16 v[134:137], a[16:19], v[82:85], v[134:137]
    buffer_load_dwordx4 v[118:121], v9, s[76:79], s88 offen offset:0 sc1
    v_mfma_f32_16x16x32_bf16 v[138:141], a[20:23], v[82:85], v[138:141]
    ds_write_b128 v15, v[194:197] offset:64
    v_mfma_f32_16x16x32_bf16 v[142:145], a[24:27], v[82:85], v[142:145]
    v_mfma_f32_16x16x32_bf16 v[146:149], a[28:31], v[82:85], v[146:149]
    ds_write_b128 v15, v[198:201] offset:128
    s_waitcnt vmcnt(8)
    v_mfma_f32_16x16x32_bf16 v[134:137], a[32:35], v[86:89], v[134:137]
    buffer_load_dwordx4 v[122:125], v9, s[76:79], s88 offen offset:2048 sc1
    v_mfma_f32_16x16x32_bf16 v[138:141], a[36:39], v[86:89], v[138:141]
    ds_write_b128 v15, v[202:205] offset:192
    v_mfma_f32_16x16x32_bf16 v[142:145], a[40:43], v[86:89], v[142:145]
    v_mfma_f32_16x16x32_bf16 v[146:149], a[44:47], v[86:89], v[146:149]
    ds_write_b128 v15, v[206:209] offset:4352
    v_mfma_f32_16x16x32_bf16 v[134:137], a[48:51], v[90:93], v[134:137]
    buffer_load_dwordx4 v[126:129], v9, s[76:79], s89 offen offset:0 sc1
    v_mfma_f32_16x16x32_bf16 v[138:141], a[52:55], v[90:93], v[138:141]
    ds_write_b128 v15, v[210:213] offset:4416
    v_mfma_f32_16x16x32_bf16 v[142:145], a[56:59], v[90:93], v[142:145]
    v_mfma_f32_16x16x32_bf16 v[146:149], a[60:63], v[90:93], v[146:149]
    ds_write_b128 v15, v[214:217] offset:4480
    s_waitcnt vmcnt(8)
    v_mfma_f32_16x16x32_bf16 v[134:137], a[64:67], v[94:97], v[134:137]
    buffer_load_dwordx4 v[130:133], v9, s[76:79], s89 offen offset:2048 sc1
    v_mfma_f32_16x16x32_bf16 v[138:141], a[68:71], v[94:97], v[138:141]
    ds_write_b128 v15, v[218:221] offset:4544
    v_mfma_f32_16x16x32_bf16 v[142:145], a[72:75], v[94:97], v[142:145]
    v_mfma_f32_16x16x32_bf16 v[146:149], a[76:79], v[94:97], v[146:149]
    s_waitcnt lgkmcnt(0)
    s_barrier
    v_mfma_f32_16x16x32_bf16 v[134:137], a[80:83], v[98:101], v[134:137]
    buffer_load_dwordx4 v[22:25], v9, s[76:79], 0 offen offset:256 sc1
    ds_read_b128 v[190:193], v16 offset:0
    v_mfma_f32_16x16x32_bf16 v[138:141], a[84:87], v[98:101], v[138:141]
    ds_read_b128 v[194:197], v16 offset:16
    ds_read_b128 v[198:201], v16 offset:8704
    v_mfma_f32_16x16x32_bf16 v[142:145], a[88:91], v[98:101], v[142:145]
    ds_read_b128 v[202:205], v16 offset:8720
    ds_read_b128 v[206:209], v16 offset:17408
    v_mfma_f32_16x16x32_bf16 v[146:149], a[92:95], v[98:101], v[146:149]
    ds_read_b128 v[210:213], v16 offset:17424
    s_waitcnt vmcnt(7)
    v_mfma_f32_16x16x32_bf16 v[134:137], a[96:99], v[102:105], v[134:137]
    buffer_load_dwordx4 v[26:29], v9, s[76:79], 0 offen offset:2304 sc1
    ds_read_b128 v[214:217], v16 offset:26112
    v_mfma_f32_16x16x32_bf16 v[138:141], a[100:103], v[102:105], v[138:141]
    ds_read_b128 v[218:221], v16 offset:26128
    v_mfma_f32_16x16x32_bf16 v[142:145], a[104:107], v[102:105], v[142:145]
    v_mfma_f32_16x16x32_bf16 v[146:149], a[108:111], v[102:105], v[146:149]
    v_mfma_f32_16x16x32_bf16 v[134:137], a[112:115], v[106:109], v[134:137]
    buffer_load_dwordx4 v[30:33], v9, s[76:79], s84 offen offset:256 sc1
    v_mfma_f32_16x16x32_bf16 v[138:141], a[116:119], v[106:109], v[138:141]
    v_mfma_f32_16x16x32_bf16 v[142:145], a[120:123], v[106:109], v[142:145]
    s_waitcnt lgkmcnt(0)
    s_barrier
    v_mfma_f32_16x16x32_bf16 v[146:149], a[124:127], v[106:109], v[146:149]
    s_waitcnt vmcnt(7)
    v_mfma_f32_16x16x32_bf16 v[134:137], a[128:131], v[110:113], v[134:137]
    buffer_load_dwordx4 v[34:37], v9, s[76:79], s84 offen offset:2304 sc1
    v_add_f32 v190, v190, v198
    v_mfma_f32_16x16x32_bf16 v[138:141], a[132:135], v[110:113], v[138:141]
    v_add_f32 v191, v191, v199
    v_add_f32 v192, v192, v200
    v_mfma_f32_16x16x32_bf16 v[142:145], a[136:139], v[110:113], v[142:145]
    v_add_f32 v193, v193, v201
    v_add_f32 v194, v194, v202
    v_mfma_f32_16x16x32_bf16 v[146:149], a[140:143], v[110:113], v[146:149]
    v_add_f32 v195, v195, v203
    v_add_f32 v196, v196, v204
    v_mfma_f32_16x16x32_bf16 v[134:137], a[144:147], v[114:117], v[134:137]
    buffer_load_dwordx4 v[38:41], v9, s[76:79], s85 offen offset:256 sc1
    v_add_f32 v197, v197, v205
    v_mfma_f32_16x16x32_bf16 v[138:141], a[148:151], v[114:117], v[138:141]
    v_add_f32 v206, v206, v214
    v_add_f32 v207, v207, v215
    v_mfma_f32_16x16x32_bf16 v[142:145], a[152:155], v[114:117], v[142:145]
    v_add_f32 v208, v208, v216
    v_add_f32 v209, v209, v217
    v_mfma_f32_16x16x32_bf16 v[146:149], a[156:159], v[114:117], v[146:149]
    v_add_f32 v210, v210, v218
    s_waitcnt vmcnt(7)
    v_mfma_f32_16x16x32_bf16 v[134:137], a[160:163], v[118:121], v[134:137]
    buffer_load_dwordx4 v[42:45], v9, s[76:79], s85 offen offset:2304 sc1
    v_add_f32 v211, v211, v219
    v_mfma_f32_16x16x32_bf16 v[138:141], a[164:167], v[118:121], v[138:141]
    v_add_f32 v212, v212, v220
    v_add_f32 v213, v213, v221
    v_mfma_f32_16x16x32_bf16 v[142:145], a[168:171], v[118:121], v[142:145]
    v_lshlrev_b32 v198, 16, v222
    v_and_b32 v199, 0xffff0000, v222
    v_mfma_f32_16x16x32_bf16 v[146:149], a[172:175], v[118:121], v[146:149]
    v_lshlrev_b32 v200, 16, v223
    v_and_b32 v201, 0xffff0000, v223
    v_mfma_f32_16x16x32_bf16 v[134:137], a[176:179], v[122:125], v[134:137]
    buffer_load_dwordx4 v[46:49], v9, s[76:79], s86 offen offset:256 sc1
    v_lshlrev_b32 v202, 16, v224
    v_mfma_f32_16x16x32_bf16 v[138:141], a[180:183], v[122:125], v[138:141]
    v_and_b32 v203, 0xffff0000, v224
    v_lshlrev_b32 v204, 16, v225
    v_mfma_f32_16x16x32_bf16 v[142:145], a[184:187], v[122:125], v[142:145]
    v_and_b32 v205, 0xffff0000, v225
    v_add_f32 v190, v190, v198
    v_mfma_f32_16x16x32_bf16 v[146:149], a[188:191], v[122:125], v[146:149]
    v_add_f32 v191, v191, v199
    s_waitcnt vmcnt(7)
    v_mfma_f32_16x16x32_bf16 v[134:137], a[192:195], v[126:129], v[134:137]
    buffer_load_dwordx4 v[50:53], v9, s[76:79], s86 offen offset:2304 sc1
    v_add_f32 v192, v192, v200
    v_mfma_f32_16x16x32_bf16 v[138:141], a[196:199], v[126:129], v[138:141]
    v_add_f32 v193, v193, v201
    v_add_f32 v194, v194, v202
    v_mfma_f32_16x16x32_bf16 v[142:145], a[200:203], v[126:129], v[142:145]
    v_add_f32 v195, v195, v203
    v_add_f32 v196, v196, v204
    v_mfma_f32_16x16x32_bf16 v[146:149], a[204:207], v[126:129], v[146:149]
    v_add_f32 v197, v197, v205
    v_add_f32 v190, v190, v206
    v_mfma_f32_16x16x32_bf16 v[134:137], a[208:211], v[130:133], v[134:137]
    buffer_load_dwordx4 v[54:57], v9, s[76:79], s87 offen offset:256 sc1
    v_add_f32 v191, v191, v207
    v_mfma_f32_16x16x32_bf16 v[138:141], a[212:215], v[130:133], v[138:141]
    v_add_f32 v192, v192, v208
    v_add_f32 v193, v193, v209
    v_mfma_f32_16x16x32_bf16 v[142:145], a[216:219], v[130:133], v[142:145]
    v_add_f32 v194, v194, v210
    v_add_f32 v195, v195, v211
    v_mfma_f32_16x16x32_bf16 v[146:149], a[220:223], v[130:133], v[146:149]
    v_add_f32 v196, v196, v212
    s_waitcnt vmcnt(7)
    v_mfma_f32_16x16x32_bf16 v[150:153], a[0:3], v[22:25], 0
    buffer_load_dwordx4 v[58:61], v9, s[76:79], s87 offen offset:2304 sc1
    v_add_f32 v197, v197, v213
    v_mfma_f32_16x16x32_bf16 v[154:157], a[4:7], v[22:25], 0
    v_cvt_pk_bf16_f32 v198, v190, v191
    v_cvt_pk_bf16_f32 v199, v192, v193
    v_mfma_f32_16x16x32_bf16 v[158:161], a[8:11], v[22:25], 0
    v_cvt_pk_bf16_f32 v200, v194, v195
    v_cvt_pk_bf16_f32 v201, v196, v197
    v_mfma_f32_16x16x32_bf16 v[162:165], a[12:15], v[22:25], 0
    buffer_store_dwordx4 v[198:201], v14, s[72:75], 0 offen sc1
    ds_write_b128 v15, v[134:137] offset:0
    v_mfma_f32_16x16x32_bf16 v[150:153], a[16:19], v[26:29], v[150:153]
    buffer_load_dwordx4 v[62:65], v9, s[76:79], s88 offen offset:256 sc1
    v_mfma_f32_16x16x32_bf16 v[154:157], a[20:23], v[26:29], v[154:157]
    ds_write_b128 v15, v[138:141] offset:64
    v_mfma_f32_16x16x32_bf16 v[158:161], a[24:27], v[26:29], v[158:161]
    v_mfma_f32_16x16x32_bf16 v[162:165], a[28:31], v[26:29], v[162:165]
    ds_write_b128 v15, v[142:145] offset:128
    s_waitcnt vmcnt(8)
    v_mfma_f32_16x16x32_bf16 v[150:153], a[32:35], v[30:33], v[150:153]
    buffer_load_dwordx4 v[66:69], v9, s[76:79], s88 offen offset:2304 sc1
    v_mfma_f32_16x16x32_bf16 v[154:157], a[36:39], v[30:33], v[154:157]
    ds_write_b128 v15, v[146:149] offset:192
    v_mfma_f32_16x16x32_bf16 v[158:161], a[40:43], v[30:33], v[158:161]
    v_mfma_f32_16x16x32_bf16 v[162:165], a[44:47], v[30:33], v[162:165]
    v_mfma_f32_16x16x32_bf16 v[150:153], a[48:51], v[34:37], v[150:153]
    buffer_load_dwordx4 v[70:73], v9, s[76:79], s89 offen offset:256 sc1
    v_mfma_f32_16x16x32_bf16 v[154:157], a[52:55], v[34:37], v[154:157]
    v_mfma_f32_16x16x32_bf16 v[158:161], a[56:59], v[34:37], v[158:161]
    v_mfma_f32_16x16x32_bf16 v[162:165], a[60:63], v[34:37], v[162:165]
    s_waitcnt vmcnt(8)
    v_mfma_f32_16x16x32_bf16 v[150:153], a[64:67], v[38:41], v[150:153]
    buffer_load_dwordx4 v[74:77], v9, s[76:79], s89 offen offset:2304 sc1
    buffer_load_dwordx4 v[226:229], v13, s[76:79], s84 offen sc1
    v_mfma_f32_16x16x32_bf16 v[154:157], a[68:71], v[38:41], v[154:157]
    v_mfma_f32_16x16x32_bf16 v[158:161], a[72:75], v[38:41], v[158:161]
    v_mfma_f32_16x16x32_bf16 v[162:165], a[76:79], v[38:41], v[162:165]
    v_mfma_f32_16x16x32_bf16 v[150:153], a[80:83], v[42:45], v[150:153]
    v_mfma_f32_16x16x32_bf16 v[154:157], a[84:87], v[42:45], v[154:157]
    v_mfma_f32_16x16x32_bf16 v[158:161], a[88:91], v[42:45], v[158:161]
    v_mfma_f32_16x16x32_bf16 v[162:165], a[92:95], v[42:45], v[162:165]
    s_waitcnt vmcnt(8)
    v_mfma_f32_16x16x32_bf16 v[150:153], a[96:99], v[46:49], v[150:153]
    v_mfma_f32_16x16x32_bf16 v[154:157], a[100:103], v[46:49], v[154:157]
    v_mfma_f32_16x16x32_bf16 v[158:161], a[104:107], v[46:49], v[158:161]
    v_mfma_f32_16x16x32_bf16 v[162:165], a[108:111], v[46:49], v[162:165]
    v_mfma_f32_16x16x32_bf16 v[150:153], a[112:115], v[50:53], v[150:153]
    v_mfma_f32_16x16x32_bf16 v[154:157], a[116:119], v[50:53], v[154:157]
    v_mfma_f32_16x16x32_bf16 v[158:161], a[120:123], v[50:53], v[158:161]
    v_mfma_f32_16x16x32_bf16 v[162:165], a[124:127], v[50:53], v[162:165]
    s_waitcnt vmcnt(6)
    v_mfma_f32_16x16x32_bf16 v[150:153], a[128:131], v[54:57], v[150:153]
    v_mfma_f32_16x16x32_bf16 v[154:157], a[132:135], v[54:57], v[154:157]
    v_mfma_f32_16x16x32_bf16 v[158:161], a[136:139], v[54:57], v[158:161]
    v_mfma_f32_16x16x32_bf16 v[162:165], a[140:143], v[54:57], v[162:165]
    v_mfma_f32_16x16x32_bf16 v[150:153], a[144:147], v[58:61], v[150:153]
    v_mfma_f32_16x16x32_bf16 v[154:157], a[148:151], v[58:61], v[154:157]
    v_mfma_f32_16x16x32_bf16 v[158:161], a[152:155], v[58:61], v[158:161]
    v_mfma_f32_16x16x32_bf16 v[162:165], a[156:159], v[58:61], v[162:165]
    s_waitcnt vmcnt(3)
    v_mfma_f32_16x16x32_bf16 v[150:153], a[160:163], v[62:65], v[150:153]
    v_mfma_f32_16x16x32_bf16 v[154:157], a[164:167], v[62:65], v[154:157]
    v_mfma_f32_16x16x32_bf16 v[158:161], a[168:171], v[62:65], v[158:161]
    v_mfma_f32_16x16x32_bf16 v[162:165], a[172:175], v[62:65], v[162:165]
    v_mfma_f32_16x16x32_bf16 v[150:153], a[176:179], v[66:69], v[150:153]
    v_mfma_f32_16x16x32_bf16 v[154:157], a[180:183], v[66:69], v[154:157]
    v_mfma_f32_16x16x32_bf16 v[158:161], a[184:187], v[66:69], v[158:161]
    v_mfma_f32_16x16x32_bf16 v[162:165], a[188:191], v[66:69], v[162:165]
    s_waitcnt vmcnt(1)
    v_mfma_f32_16x16x32_bf16 v[150:153], a[192:195], v[70:73], v[150:153]
    v_mfma_f32_16x16x32_bf16 v[154:157], a[196:199], v[70:73], v[154:157]
    v_mfma_f32_16x16x32_bf16 v[158:161], a[200:203], v[70:73], v[158:161]
    v_mfma_f32_16x16x32_bf16 v[162:165], a[204:207], v[70:73], v[162:165]
    v_mfma_f32_16x16x32_bf16 v[150:153], a[208:211], v[74:77], v[150:153]
    v_mfma_f32_16x16x32_bf16 v[154:157], a[212:215], v[74:77], v[154:157]
    v_mfma_f32_16x16x32_bf16 v[158:161], a[216:219], v[74:77], v[158:161]
    v_mfma_f32_16x16x32_bf16 v[162:165], a[220:223], v[74:77], v[162:165]
    s_nop 4
    ds_write_b128 v15, v[150:153] offset:4352
    ds_write_b128 v15, v[154:157] offset:4416
    ds_write_b128 v15, v[158:161] offset:4480
    ds_write_b128 v15, v[162:165] offset:4544
    s_waitcnt lgkmcnt(0)
    s_barrier
    ds_read_b128 v[22:25], v16 offset:0
    ds_read_b128 v[26:29], v16 offset:16
    ds_read_b128 v[30:33], v16 offset:8704
    ds_read_b128 v[34:37], v16 offset:8720
    ds_read_b128 v[38:41], v16 offset:17408
    ds_read_b128 v[42:45], v16 offset:17424
    ds_read_b128 v[46:49], v16 offset:26112
    ds_read_b128 v[50:53], v16 offset:26128
    s_waitcnt lgkmcnt(0)
    s_waitcnt vmcnt(0)
    v_pk_add_f32 v[22:23], v[22:23], v[30:31]
    v_pk_add_f32 v[24:25], v[24:25], v[32:33]
    v_pk_add_f32 v[26:27], v[26:27], v[34:35]
    v_pk_add_f32 v[28:29], v[28:29], v[36:37]
    v_pk_add_f32 v[38:39], v[38:39], v[46:47]
    v_pk_add_f32 v[40:41], v[40:41], v[48:49]
    v_pk_add_f32 v[42:43], v[42:43], v[50:51]
    v_pk_add_f32 v[44:45], v[44:45], v[52:53]
    v_lshlrev_b32 v30, 16, v226
    v_and_b32 v31, 0xffff0000, v226
    v_lshlrev_b32 v32, 16, v227
    v_and_b32 v33, 0xffff0000, v227
    v_lshlrev_b32 v34, 16, v228
    v_and_b32 v35, 0xffff0000, v228
    v_lshlrev_b32 v36, 16, v229
    v_and_b32 v37, 0xffff0000, v229
    v_pk_add_f32 v[22:23], v[22:23], v[30:31]
    v_pk_add_f32 v[24:25], v[24:25], v[32:33]
    v_pk_add_f32 v[26:27], v[26:27], v[34:35]
    v_pk_add_f32 v[28:29], v[28:29], v[36:37]
    v_pk_add_f32 v[22:23], v[22:23], v[38:39]
    v_pk_add_f32 v[24:25], v[24:25], v[40:41]
    v_pk_add_f32 v[26:27], v[26:27], v[42:43]
    v_pk_add_f32 v[28:29], v[28:29], v[44:45]
    v_cvt_pk_bf16_f32 v30, v22, v23
    v_cvt_pk_bf16_f32 v31, v24, v25
    v_cvt_pk_bf16_f32 v32, v26, v27
    v_cvt_pk_bf16_f32 v33, v28, v29
    buffer_store_dwordx4 v[30:33], v14, s[72:75], s55 offen sc1
L_END:
    s_endpgm
L3:
    buffer_load_dword v53, v52, s[76:79], s19 offen sc1
    s_waitcnt vmcnt(0)
    v_xor_b32 v54, s7, v53
    v_cmp_lt_u32 vcc, 15, v54
    s_cbranch_vccz L5
    s_sub_u32 s9, s9, 1
    s_cbranch_scc0 L3
    s_branch L_END
L5:
    v_cmp_ne_u32 vcc, s12, v53
    s_cbranch_vccz L4
    s_mov_b32 s11, 1
    s_not_b32 s8, s7
    s_branch L4
L6:
    s_waitcnt vmcnt(0)
    buffer_wbl2 sc1
    s_waitcnt vmcnt(0)
    buffer_store_dword v4, v3, s[76:79], s17 offen offset:0 sc1
    s_branch L7
L8:
    buffer_load_dword v5, v17, s[76:79], s44 offen offset:0 sc1
    s_waitcnt vmcnt(0)
    v_cmp_ne_u32 vcc, s7, v5
    s_cbranch_vccz L10
    s_sub_u32 s9, s9, 1
    s_cbranch_scc0 L8
    s_branch L_END
L10:
    s_cmp_eq_u32 s11, 0
    s_cbranch_scc1 L9
    buffer_inv sc1
    s_waitcnt vmcnt(0)
    s_branch L9
L11:
    buffer_load_dword v5, v146, s[76:79], s49 offen offset:0 sc1
    s_waitcnt vmcnt(0)
    v_cmp_ne_u32 vcc, s7, v5
    s_cbranch_vccz L13
    s_sub_u32 s9, s9, 1
    s_cbranch_scc0 L11
    s_branch L_END
L13:
    s_branch L12
L14:
    buffer_load_dword v229, v226, s[76:79], s53 offen offset:0 sc1
    s_waitcnt vmcnt(0)
    v_cmp_ne_u32 vcc, s7, v229
    s_cbranch_vccz L16
    s_sub_u32 s9, s9, 1
    s_cbranch_scc0 L14
    s_branch L_END
L16:
    s_branch L15
L17:
    s_waitcnt vmcnt(0)
    buffer_wbl2 sc1
    s_waitcnt vmcnt(0)
    buffer_store_dword v4, v3, s[76:79], s95 offen offset:0 sc1
    s_branch L18
L19:
    s_waitcnt vmcnt(0)
    buffer_wbl2 sc1
    s_waitcnt vmcnt(0)
    buffer_store_dword v4, v3, s[76:79], s95 offen offset:512 sc1
    s_branch L20
L21:
    buffer_load_dword v5, v17, s[76:79], s94 offen offset:0 sc1
    s_waitcnt vmcnt(0)
    v_cmp_ne_u32 vcc, s7, v5
    s_cbranch_vccz L23
    s_sub_u32 s9, s9, 1
    s_cbranch_scc0 L21
    s_branch L_END
L23:
    s_cmp_eq_u32 s11, 0
    s_cbranch_scc1 L22
    buffer_inv sc1
    s_waitcnt vmcnt(0)
    s_branch L22
L24:
    buffer_load_dword v5, v17, s[76:79], s94 offen offset:512 sc1
    s_waitcnt vmcnt(0)
    v_cmp_ne_u32 vcc, s7, v5
    s_cbranch_vccz L26
    s_sub_u32 s9, s9, 1
    s_cbranch_scc0 L24
    s_branch L_END
L26:
    s_cmp_eq_u32 s11, 0
    s_cbranch_scc1 L25
    buffer_inv sc1
    s_waitcnt vmcnt(0)
    s_branch L25
L33:
    s_waitcnt vmcnt(0)
    buffer_wbl2 sc1
    s_waitcnt vmcnt(0)
    buffer_store_dword v4, v3, s[76:79], s97 offen offset:0 sc1
    s_branch L34
L30:
    buffer_load_dword v5, v18, s[76:79], s96 offen offset:0 sc1
    s_waitcnt vmcnt(0)
    v_cmp_ne_u32 vcc, s7, v5
    s_cbranch_vccz L32
    s_sub_u32 s9, s9, 1
    s_cbranch_scc0 L30
    s_branch L_END
L32:
    s_cmp_eq_u32 s11, 0
    s_cbranch_scc1 L31
    buffer_inv sc1
    s_waitcnt vmcnt(0)
    s_branch L31
L35:
    s_waitcnt vmcnt(0)
    buffer_wbl2 sc1
    s_waitcnt vmcnt(0)
    buffer_store_dword v4, v3, s[76:79], s97 offen offset:512 sc1
    s_branch L36
L37:
    buffer_load_dword v5, v18, s[76:79], s96 offen offset:512 sc1
    s_waitcnt vmcnt(0)
    v_cmp_ne_u32 vcc, s7, v5
    s_cbranch_vccz L39
    s_sub_u32 s9, s9, 1
    s_cbranch_scc0 L37
    s_branch L_END
L39:
    s_cmp_eq_u32 s11, 0
    s_cbranch_scc1 L38
    buffer_inv sc1
    s_waitcnt vmcnt(0)
    s_branch L38
L46:
    s_waitcnt vmcnt(0)
    buffer_wbl2 sc1
    s_waitcnt vmcnt(0)
    buffer_store_dword v4, v3, s[76:79], s97 offen offset:1024 sc1
    s_branch L47
L48:
    s_waitcnt vmcnt(0)
    buffer_wbl2 sc1
    s_waitcnt vmcnt(0)
    buffer_store_dword v4, v3, s[76:79], s97 offen offset:1536 sc1
    s_branch L49
L40:
    buffer_load_dword v5, v18, s[76:79], s96 offen offset:1024 sc1
    s_waitcnt vmcnt(0)
    v_cmp_ne_u32 vcc, s7, v5
    s_cbranch_vccz L42
    s_sub_u32 s9, s9, 1
    s_cbranch_scc0 L40
    s_branch L_END
L42:
    s_cmp_eq_u32 s11, 0
    s_cbranch_scc1 L41
    buffer_inv sc1
    s_waitcnt vmcnt(0)
    s_branch L41
L43:
    buffer_load_dword v5, v18, s[76:79], s96 offen offset:1536 sc1
    s_waitcnt vmcnt(0)
    v_cmp_ne_u32 vcc, s7, v5
    s_cbranch_vccz L45
    s_sub_u32 s9, s9, 1
    s_cbranch_scc0 L43
    s_branch L_END
L45:
    s_cmp_eq_u32 s11, 0
    s_cbranch_scc1 L44
    buffer_inv sc1
    s_waitcnt vmcnt(0)
    s_branch L44
L53:
    s_waitcnt vmcnt(0)
    buffer_wbl2 sc1
    s_waitcnt vmcnt(0)
    buffer_store_dword v4, v3, s[76:79], s99 offen offset:0 sc1
    s_branch L54
L50:
    buffer_load_dword v5, v18, s[76:79], s98 offen offset:0 sc1
    s_waitcnt vmcnt(0)
    v_cmp_ne_u32 vcc, s7, v5
    s_cbranch_vccz L52
    s_sub_u32 s9, s9, 1
    s_cbranch_scc0 L50
    s_branch L_END
L52:
    s_cmp_eq_u32 s11, 0
    s_cbranch_scc1 L51
    buffer_inv sc1
    s_waitcnt vmcnt(0)
    s_branch L51
L55:
    s_waitcnt vmcnt(0)
    buffer_wbl2 sc1
    s_waitcnt vmcnt(0)
    buffer_store_dword v4, v3, s[76:79], s95 offen offset:1024 sc1
    s_branch L56
L57:
    buffer_load_dword v5, v17, s[76:79], s94 offen offset:1024 sc1
    s_waitcnt vmcnt(0)
    v_cmp_ne_u32 vcc, s7, v5
    s_cbranch_vccz L59
    s_sub_u32 s9, s9, 1
    s_cbranch_scc0 L57
    s_branch L_END
L59:
    s_cmp_eq_u32 s11, 0
    s_cbranch_scc1 L58
    buffer_inv sc1
    s_waitcnt vmcnt(0)
    s_branch L58
L63:
    s_waitcnt vmcnt(0)
    buffer_wbl2 sc1
    s_waitcnt vmcnt(0)
    buffer_store_dword v4, v3, s[76:79], s99 offen offset:512 sc1
    s_branch L64
L60:
    buffer_load_dword v5, v18, s[76:79], s98 offen offset:512 sc1
    s_waitcnt vmcnt(0)
    v_cmp_ne_u32 vcc, s7, v5
    s_cbranch_vccz L62
    s_sub_u32 s9, s9, 1
    s_cbranch_scc0 L60
    s_branch L_END
L62:
    s_cmp_eq_u32 s11, 0
    s_cbranch_scc1 L61
    buffer_inv sc1
    s_waitcnt vmcnt(0)
    s_branch L61
L68:
    s_waitcnt vmcnt(0)
    buffer_wbl2 sc1
    s_waitcnt vmcnt(0)
    buffer_store_dword v4, v3, s[76:79], s95 offen offset:1536 sc1
    s_branch L69
L65:
    buffer_load_dword v5, v17, s[76:79], s94 offen offset:1536 sc1
    s_waitcnt vmcnt(0)
    v_cmp_ne_u32 vcc, s7, v5
    s_cbranch_vccz L67
    s_sub_u32 s9, s9, 1
    s_cbranch_scc0 L65
    s_branch L_END
L67:
    s_cmp_eq_u32 s11, 0
    s_cbranch_scc1 L66
    buffer_inv sc1
    s_waitcnt vmcnt(0)
    s_branch L66
L73:
    s_waitcnt vmcnt(0)
    buffer_wbl2 sc1
    s_waitcnt vmcnt(0)
    buffer_store_dword v4, v3, s[76:79], s97 offen offset:2048 sc1
    s_branch L74
L70:
    buffer_load_dword v5, v18, s[76:79], s96 offen offset:2048 sc1
    s_waitcnt vmcnt(0)
    v_cmp_ne_u32 vcc, s7, v5
    s_cbranch_vccz L72
    s_sub_u32 s9, s9, 1
    s_cbranch_scc0 L70
    s_branch L_END
L72:
    s_cmp_eq_u32 s11, 0
    s_cbranch_scc1 L71
    buffer_inv sc1
    s_waitcnt vmcnt(0)
    s_branch L71
L75:
    s_waitcnt vmcnt(0)
    buffer_wbl2 sc1
    s_waitcnt vmcnt(0)
    buffer_store_dword v4, v3, s[76:79], s97 offen offset:2560 sc1
    s_branch L76
L77:
    buffer_load_dword v5, v18, s[76:79], s96 offen offset:2560 sc1
    s_waitcnt vmcnt(0)
    v_cmp_ne_u32 vcc, s7, v5
    s_cbranch_vccz L79
    s_sub_u32 s9, s9, 1
    s_cbranch_scc0 L77
    s_branch L_END
L79:
    s_cmp_eq_u32 s11, 0
    s_cbranch_scc1 L78
    buffer_inv sc1
    s_waitcnt vmcnt(0)
    s_branch L78
L86:
    s_waitcnt vmcnt(0)
    buffer_wbl2 sc1
    s_waitcnt vmcnt(0)
    buffer_store_dword v4, v3, s[76:79], s97 offen offset:3072 sc1
    s_branch L87
L88:
    s_waitcnt vmcnt(0)
    buffer_wbl2 sc1
    s_waitcnt vmcnt(0)
    buffer_store_dword v4, v3, s[76:79], s97 offen offset:3584 sc1
    s_branch L89
L80:
    buffer_load_dword v5, v18, s[76:79], s96 offen offset:3072 sc1
    s_waitcnt vmcnt(0)
    v_cmp_ne_u32 vcc, s7, v5
    s_cbranch_vccz L82
    s_sub_u32 s9, s9, 1
    s_cbranch_scc0 L80
    s_branch L_END
L82:
    s_cmp_eq_u32 s11, 0
    s_cbranch_scc1 L81
    buffer_inv sc1
    s_waitcnt vmcnt(0)
    s_branch L81
L83:
    buffer_load_dword v5, v18, s[76:79], s96 offen offset:3584 sc1
    s_waitcnt vmcnt(0)
    v_cmp_ne_u32 vcc, s7, v5
    s_cbranch_vccz L85
    s_sub_u32 s9, s9, 1
    s_cbranch_scc0 L83
    s_branch L_END
L85:
    s_cmp_eq_u32 s11, 0
    s_cbranch_scc1 L84
    buffer_inv sc1
    s_waitcnt vmcnt(0)
    s_branch L84
L_LAST:
.section .rodata,"a"
.p2align 6
.amdhsa_kernel interleave_layers__ssm_conv_h3__swiglu_ffn__prompt_kernel
  .amdhsa_next_free_vgpr 512
  .amdhsa_next_free_sgpr 102
  .amdhsa_accum_offset 256
  .amdhsa_group_segment_fixed_size 0
  .amdhsa_kernarg_size 104
  .amdhsa_user_sgpr_count 2
  .amdhsa_user_sgpr_kernarg_segment_ptr 1
  .amdhsa_system_sgpr_workgroup_id_x 1
.end_amdhsa_kernel
```
